```python
import torch

def _softmax(x, axis=-1):
    return torch.softmax(x, dim=axis)
def _gelu(x):
    return torch.nn.functional.gelu(x, approximate="tanh")
def _silu(x):
    return torch.nn.functional.silu(x)
def _sigmoid(x):
    return torch.sigmoid(x)
def _layernorm(x, axis=-1, eps=1e-5):
    m = x.mean(dim=axis, keepdim=True)
    v = x.var(dim=axis, keepdim=True, unbiased=False)
    return (x - m) / torch.sqrt(v + eps)
def _scatter_add(tgt, idx, src, axis=0):
    return tgt.clone().index_add_(axis, idx, src)
def _segment_sum(src, seg, n):
    out = torch.zeros((n,) + src.shape[1:], dtype=src.dtype)
    return out.index_add_(0, seg, src)
def _pad(x, pw):
    flat = tuple(v for pair in reversed(pw) for v in pair)
    return torch.nn.functional.pad(x, flat)

kernel_name = 'sequential_preLN__sliding_block__glu_gated_geglu__prompt'

def setup_inputs():

    _w = (lambda a: (lambda t: t.to(torch.bfloat16) if t.is_floating_point() else t)(torch.as_tensor(a)))
    def _A_setup():
        B, S, D = 1, 2048, 448
        return {
            "x": _w((lambda *s: torch.randn(*s, dtype=torch.bfloat16) * 0.05)(B, S, D)),
            "wqkv": _w((lambda *s: torch.randn(*s, dtype=torch.bfloat16) * 0.05)(D, 3 * D)),
            "wo": _w((lambda *s: torch.randn(*s, dtype=torch.bfloat16) * 0.05)(D, D)),
        }
    _A_in = _A_setup()

    def _B_setup():
        B, S, Dm, Df = 1, 2048, 448, 1792
        return {
            "x": _w((lambda *s: torch.randn(*s, dtype=torch.bfloat16) * 0.05)(B, S, Dm)),
            "w_gate": _w((lambda *s: torch.randn(*s, dtype=torch.bfloat16) * 0.8)(Dm, Df) * (Dm ** -0.5)),
            "w_up": _w((lambda *s: torch.randn(*s, dtype=torch.bfloat16) * 0.8)(Dm, Df) * (Dm ** -0.5)),
            "w_down": _w((lambda *s: torch.randn(*s, dtype=torch.bfloat16) * 0.8)(Df, Dm) * (Df ** -0.5)),
        }
    _B_in = _B_setup()

    return {
        "A_x": _A_in["x"],
        "A_wqkv": _A_in["wqkv"],
        "A_wo": _A_in["wo"],
        "B_x": _B_in["x"],
        "B_w_gate": _B_in["w_gate"],
        "B_w_up": _B_in["w_up"],
        "B_w_down": _B_in["w_down"],
    }

def reference(A_x, A_wqkv, A_wo, B_x, B_w_gate, B_w_up, B_w_down):
    def _A_ref(x, wqkv, wo):
        B, S, D = x.shape
        H = 16; Dh = D // H; W = 256
        qkv = (lambda x, *d: x.permute(*d))((x @ wqkv).reshape(B, S, 3, H, Dh), 2, 0, 3, 1, 4)
        q, k, v = qkv[0], qkv[1], qkv[2]
        scores = torch.einsum("bhqd,bhkd->bhqk", q, k) * (Dh ** -0.5)
        idx = torch.arange(S)
        mask = (idx[:, None] - idx[None, :] >= 0) & (idx[:, None] - idx[None, :] < W)
        scores = torch.where(mask[None, None], scores, -1e9)
        p = _softmax(scores, axis=-1)
        o = torch.einsum("bhqk,bhkd->bhqd", p, v)
        return (lambda x, *d: x.permute(*d))(o, 0, 2, 1, 3).reshape(B, S, D) @ wo

    def _B_ref(x, w_gate, w_up, w_down):
        g = torch.einsum("bsd,df->bsf", x, w_gate)
        u = torch.einsum("bsd,df->bsf", x, w_up)
        h = _gelu(g) * u
        return torch.einsum("bsf,fd->bsd", h, w_down)

    x = A_x
    h = x + _A_ref(_layernorm(x, axis=-1), A_wqkv, A_wo)
    h2 = h + _B_ref(_layernorm(h, axis=-1), B_w_gate, B_w_up, B_w_down)
    return h2
```

```asm
; @launch grid=(256,1,1) block=(256,1,1) lds=163840
.amdgcn_target "amdgcn-amd-amdhsa--gfx950"
.text
.globl sequential_preLN__sliding_block__glu_gated_geglu__prompt_kernel
.p2align 8
.type sequential_preLN__sliding_block__glu_gated_geglu__prompt_kernel,@function
sequential_preLN__sliding_block__glu_gated_geglu__prompt_kernel:
    s_cmp_ge_u32 s2, 256
    s_cbranch_scc1 L_exit
    s_load_dwordx16 s[16:31], s[0:1], 0
    s_load_dwordx4 s[32:35], s[0:1], 64
    s_getpc_b64 s[12:13]
L_code_pc:
    s_lshr_b32 s11, s2, 3
    s_lshl_b32 s11, s11, 12
    v_lshl_add_u32 v232, v0, 4, s11
    v_min_u32 v232, L_code_end-L_code_pc-16, v232
    v_mov_b32 v233, s13
    v_add_co_u32 v232, vcc, s12, v232
    s_nop 1
    v_addc_co_u32 v233, vcc, 0, v233, vcc
    global_load_dwordx4 v[234:237], v[232:233], off
    v_lshrrev_b32 v2, 6, v0
    v_and_b32 v0, 63, v0
    v_readfirstlane_b32 s3, v2
    v_lshlrev_b32 v1, 4, v0
    s_and_b32 s4, s2, 7
    s_lshr_b32 s5, s2, 3
    s_and_b32 s11, s5, 3
    s_lshl_b32 s6, s4, 2
    s_add_u32 s6, s6, s11
    s_lshr_b32 s7, s5, 2
    s_mov_b32 s10, 0x40000
    s_cmp_ge_u32 s7, 7
    s_cbranch_scc1 L_idle1
    v_lshrrev_b32 v2, 3, v0
    v_and_b32 v3, 7, v0
    v_mul_u32_u24 v178, 896, v2
    v_lshl_add_u32 v178, v3, 4, v178
    v_add_u32 v179, 7168, v178
    s_lshl_b32 s11, s6, 6
    s_lshl_b32 s12, s3, 4
    s_add_u32 s11, s11, s12
    s_mul_i32 s14, s11, 896
    s_add_u32 s15, s4, s7
    s_sub_u32 s13, s15, 7
    s_cselect_b32 s15, s15, s13
    s_lshl_b32 s15, s15, 7
    s_add_u32 s92, s14, s15
    s_mul_i32 s84, s15, 1344
    s_add_u32 s15, s15, 128
    s_cmp_eq_u32 s15, 896
    s_cselect_b32 s15, 0, s15
    s_add_u32 s93, s14, s15
    s_mul_i32 s85, s15, 1344
    s_add_u32 s15, s15, 128
    s_cmp_eq_u32 s15, 896
    s_cselect_b32 s15, 0, s15
    s_add_u32 s94, s14, s15
    s_mul_i32 s86, s15, 1344
    s_add_u32 s15, s15, 128
    s_cmp_eq_u32 s15, 896
    s_cselect_b32 s15, 0, s15
    s_add_u32 s95, s14, s15
    s_mul_i32 s87, s15, 1344
    s_add_u32 s15, s15, 128
    s_cmp_eq_u32 s15, 896
    s_cselect_b32 s15, 0, s15
    s_add_u32 s96, s14, s15
    s_mul_i32 s88, s15, 1344
    s_add_u32 s15, s15, 128
    s_cmp_eq_u32 s15, 896
    s_cselect_b32 s15, 0, s15
    s_add_u32 s97, s14, s15
    s_mul_i32 s89, s15, 1344
    s_add_u32 s15, s15, 128
    s_cmp_eq_u32 s15, 896
    s_cselect_b32 s15, 0, s15
    s_add_u32 s98, s14, s15
    s_mul_i32 s90, s15, 1344
    s_add_u32 s68, s84, 4096
    s_add_u32 s69, s84, 89088
    s_add_u32 s70, s85, 2048
    s_add_u32 s71, s85, 87040
    s_add_u32 s72, s86, 4096
    s_add_u32 s73, s86, 89088
    s_add_u32 s74, s87, 2048
    s_mul_i32 s83, s3, 7168
    s_mul_i32 s11, s3, 21504
    s_lshl_b32 s12, s7, 7
    s_add_u32 s11, s11, s12
    v_bfe_u32 v176, v0, 4, 1
    v_lshlrev_b32 v176, 2, v176
    v_xor_b32 v176, v176, v3
    v_mul_u32_u24 v177, 2688, v2
    v_lshl_add_u32 v176, v176, 4, v177
    v_add_u32 v181, s11, v176
    v_add_u32 v180, 896, v181
    s_waitcnt lgkmcnt(0)
    s_mov_b32 s36, s16
    s_and_b32 s37, s17, 0xffff
    s_mov_b32 s38, 1835008
    s_mov_b32 s39, 0x20000
    buffer_load_dwordx4 v[16:19], v178, s[36:39], s92 offen
    buffer_load_dwordx4 v[20:23], v179, s[36:39], s92 offen
    buffer_load_dwordx4 v[24:27], v178, s[36:39], s93 offen
    buffer_load_dwordx4 v[28:31], v179, s[36:39], s93 offen
    buffer_load_dwordx4 v[32:35], v178, s[36:39], s94 offen
    buffer_load_dwordx4 v[36:39], v179, s[36:39], s94 offen
    buffer_load_dwordx4 v[40:43], v178, s[36:39], s95 offen
    buffer_load_dwordx4 v[44:47], v179, s[36:39], s95 offen
    buffer_load_dwordx4 v[48:51], v178, s[36:39], s96 offen
    buffer_load_dwordx4 v[52:55], v179, s[36:39], s96 offen
    s_sub_u32 s18, s18, 4096
    s_subb_u32 s19, s19, 0
    s_mov_b32 s52, s18
    s_and_b32 s53, s19, 0xffff
    s_mov_b32 s54, 1208320
    s_mov_b32 s55, 0x20000
    s_lshl_b32 s11, s2, 2
    s_add_u32 s11, s11, s3
    s_mul_i32 s11, s11, 1344
    s_add_u32 s11, s11, 4096
    v_lshlrev_b32 v190, 7, v0
    s_mov_b64 exec, 0x7ff
    buffer_load_dword v191, v190, s[52:55], s11 offen
    s_mov_b64 exec, -1
    s_add_u32 s75, s87, 90112
    s_add_u32 s76, s88, 3072
    s_add_u32 s77, s88, 88064
    s_add_u32 s78, s89, 1024
    s_add_u32 s79, s89, 90112
    s_add_u32 s80, s90, 3072
    s_add_u32 s81, s90, 88064
    s_mov_b32 s60, s24
    s_and_b32 s61, s25, 0xffff
    s_mov_b32 s62, 1605632
    s_mov_b32 s63, 0x20000
    s_mov_b32 s64, s26
    s_and_b32 s65, s27, 0xffff
    s_mov_b32 s66, 1605632
    s_mov_b32 s67, 0x20000
    s_mov_b32 s40, s34
    s_and_b32 s41, s35, 0xffff
    s_mov_b32 s42, 29622272
    s_mov_b32 s43, 0x20000
    s_mov_b32 s44, s30
    s_and_b32 s45, s31, 0xffff
    s_mov_b32 s46, 1835008
    s_mov_b32 s47, 0x20000
    s_and_b32 s11, s5, 1
    s_lshl_b32 s12, s7, 1
    s_add_u32 s12, s12, s11
    s_lshr_b32 s13, s6, 1
    s_lshr_b32 s8, s5, 1
    s_lshl_b32 s9, s4, 1
    s_add_u32 s9, s9, s11
    s_and_b32 s11, s4, 1
    s_lshl_b32 s11, s11, 3
    s_add_u32 s11, s11, s7
    s_lshr_b32 s12, s4, 1
    s_lshl_b32 s12, s12, 2
    s_and_b32 s13, s5, 3
    s_add_u32 s4, s12, s13
    s_mov_b32 s5, s11
    s_lshr_b32 s11, s3, 1
    s_lshl_b32 s11, s11, 10
    v_xor_b32 v248, s11, v1
    v_xor_b32 v249, 1024, v248
    v_add_u32 v182, 1792, v181
    v_lshrrev_b32 v10, 4, v0
    v_xor_b32 v10, v3, v10
    v_lshlrev_b32 v11, 7, v2
    s_lshl_b32 s11, s3, 11
    s_add_u32 s11, s11, 114688
    v_add_u32 v11, s11, v11
    v_lshl_add_u32 v152, v10, 4, v11
    v_xor_b32 v153, 64, v152
    v_add_u32 v153, 1024, v153
    v_and_b32 v14, 31, v0
    v_lshrrev_b32 v15, 5, v0
    v_bfe_u32 v2, v0, 1, 3
    v_xor_b32 v15, v15, v2
    s_and_b32 s11, s3, 1
    s_lshl_b32 s11, s11, 12
    s_add_u32 s11, s11, 114688
    v_lshlrev_b32 v14, 7, v14
    v_add_u32 v14, s11, v14
    v_xor_b32 v2, 0, v15
    v_lshl_add_u32 v154, v2, 4, v14
    v_xor_b32 v2, 2, v15
    v_lshl_add_u32 v155, v2, 4, v14
    v_xor_b32 v2, 4, v15
    v_lshl_add_u32 v156, v2, 4, v14
    v_xor_b32 v2, 6, v15
    v_lshl_add_u32 v157, v2, 4, v14
    v_lshrrev_b32 v2, 5, v0
    v_lshlrev_b32 v2, 3, v2
    v_bfe_u32 v3, v0, 2, 2
    v_add_u32 v2, v2, v3
    v_mul_u32_u24 v14, 128, v2
    v_bfe_u32 v2, v0, 4, 1
    v_mul_u32_u24 v2, 32, v2
    v_add_u32 v14, v14, v2
    v_and_b32 v2, 1, v0
    v_lshl_add_u32 v14, v2, 4, v14
    v_bfe_u32 v2, v0, 1, 1
    v_lshl_add_u32 v14, v2, 3, v14
    v_bfe_u32 v2, v0, 3, 1
    s_lshr_b32 s11, s3, 1
    v_xor_b32 v2, s11, v2
    v_lshl_add_u32 v158, v2, 6, v14
    v_lshrrev_b32 v2, 5, v0
    v_mul_u32_u24 v2, 6144, v2
    v_add_u32 v158, v2, v158
    v_add_u32 v159, 57344, v158
    v_mov_b32 v161, 0x3f803f80
    v_mov_b32 v170, 0xffff0000
    s_lshl_b32 s13, s6, 1
    s_and_b32 s12, s3, 1
    s_add_u32 s13, s13, s12
    s_lshr_b32 s12, s3, 1
    s_lshl_b32 s11, s7, 1
    s_add_u32 s12, s12, s11
    s_mul_i32 vcc_lo, s13, 86016
    s_lshl_b32 s11, s12, 11
    s_add_u32 vcc_lo, vcc_lo, s11
    s_add_u32 s82, vcc_lo, 28672
    s_add_u32 vcc_hi, vcc_lo, 57344
    s_lshl_b32 s16, s13, 4
    s_add_u32 s16, s16, s12
    s_lshl_b32 s16, s16, 10
    s_add_u32 s16, s16, 22423552
    s_mov_b32 s49, s16
    buffer_load_dwordx4 v[56:59], v178, s[36:39], s97 offen
    buffer_load_dwordx4 v[60:63], v179, s[36:39], s97 offen
    buffer_load_dwordx4 v[64:67], v178, s[36:39], s98 offen
    buffer_load_dwordx4 v[68:71], v179, s[36:39], s98 offen
    s_mul_i32 s28, s9, 7
    s_lshr_b32 s28, s28, 1
    s_lshl_b32 s11, s8, 2
    s_add_u32 s12, s11, s3
    s_mul_i32 s13, s3, 3
    s_add_u32 s11, s11, s13
    s_sub_i32 s18, s11, 8
    s_max_i32 s13, s18, 0
    s_lshl_b32 s13, s13, 14
    s_add_u32 s13, s13, 22423552
    s_lshl_b32 s14, s12, 14
    s_add_u32 s14, s14, 22423552
    s_add_u32 s15, s28, 0
    s_lshr_b32 s15, s15, 2
    s_lshl_b32 s15, s15, 10
    s_add_u32 s20, s15, s13
    s_add_u32 s22, s15, s14
    s_add_u32 s15, s28, 3
    s_lshr_b32 s15, s15, 2
    s_lshl_b32 s15, s15, 10
    s_add_u32 s21, s15, s13
    s_add_u32 s23, s15, s14
    s_mov_b32 s24, s12
    s_lshl_b32 s28, s28, 9
    s_mul_i32 s19, s12, 86016
    s_add_u32 s19, s19, s28
    s_add_i32 s13, s18, 0
    s_mul_i32 s14, s13, 86016
    s_add_u32 s14, s14, s28
    s_add_u32 s14, s14, 28672
    s_cmp_lt_i32 s13, 0
    s_cselect_b32 s29, 2146435072, s14
    s_add_i32 s13, s18, 1
    s_mul_i32 s14, s13, 86016
    s_add_u32 s14, s14, s28
    s_add_u32 s14, s14, 28672
    s_cmp_lt_i32 s13, 0
    s_cselect_b32 s30, 2146435072, s14
    s_add_i32 s13, s18, 2
    s_mul_i32 s14, s13, 86016
    s_add_u32 s14, s14, s28
    s_add_u32 s14, s14, 28672
    s_cmp_lt_i32 s13, 0
    s_cselect_b32 s31, 2146435072, s14
    s_mul_i32 s17, s3, 12288
    v_lshrrev_b32 v5, 5, v0
    v_lshlrev_b32 v5, 6, v5
    v_xor_b32 v4, v1, v5
    v_xor_b32 v5, 128, v4
    s_bitcmp1_b32 s9, 0
    s_cselect_b64 s[26:27], -1, 0
    s_min_u32 s18, s7, 6
    s_lshl_b32 s18, s18, 2
    s_and_b32 s11, s3, 2
    s_add_u32 s18, s18, s11
    s_lshl_b32 s18, s18, 8
    s_add_u32 s18, s18, 24840192
    v_and_b32 v2, 31, v0
    v_lshrrev_b32 v3, 5, v0
    v_lshlrev_b32 v3, 2, v3
    v_sub_u32 v2, v3, v2
    s_mov_b32 s11, 0x03020706
    v_add_u32 v3, -1, v2
    v_add_u32 v8, 0, v2
    v_perm_b32 v224, v3, v8, s11
    v_add_u32 v3, 1, v2
    v_add_u32 v8, 2, v2
    v_perm_b32 v225, v3, v8, s11
    v_add_u32 v3, 7, v2
    v_add_u32 v8, 8, v2
    v_perm_b32 v226, v3, v8, s11
    v_add_u32 v3, 9, v2
    v_add_u32 v8, 10, v2
    v_perm_b32 v227, v3, v8, s11
    v_add_u32 v3, 15, v2
    v_add_u32 v8, 16, v2
    v_perm_b32 v228, v3, v8, s11
    v_add_u32 v3, 17, v2
    v_add_u32 v8, 18, v2
    v_perm_b32 v229, v3, v8, s11
    v_add_u32 v3, 23, v2
    v_add_u32 v8, 24, v2
    v_perm_b32 v230, v3, v8, s11
    v_add_u32 v3, 25, v2
    v_add_u32 v8, 26, v2
    v_perm_b32 v231, v3, v8, s11
    s_bitcmp1_b32 s9, 0
    s_cselect_b32 s12, -1, 0
    s_mov_b32 s13, 0
    v_cndmask_b32 v6, -1, 0, s[12:13]
    s_cselect_b32 s13, 0, -1
    s_mov_b32 s12, 0
    v_cndmask_b32 v7, -1, 0, s[12:13]
    s_cselect_b32 s11, 0, 1544
    s_mul_i32 s12, s3, 12288
    s_add_u32 s11, s11, s12
    s_add_u32 s11, s11, 116736
    v_and_b32 v8, 31, v0
    v_lshlrev_b32 v8, 4, v8
    v_add_u32 v8, s11, v8
    v_lshrrev_b32 v9, 5, v0
    v_lshl_add_u32 v9, v9, 12, v8
    v_mov_b32 v10, 0x3f80
    v_mov_b32 v11, 0
    s_lshl_b32 s11, s3, 12
    s_add_u32 s11, s11, 114688
    v_add_u32 v12, s11, v1
    v_and_b32 v2, 1, v0
    v_bfe_u32 v3, v0, 4, 1
    v_lshrrev_b32 v13, 5, v0
    v_xor_b32 v13, v13, v2
    v_lshlrev_b32 v13, 6, v13
    v_lshl_add_u32 v13, v3, 7, v13
    v_lshl_add_u32 v13, v2, 9, v13
    v_lshl_add_u32 v13, v3, 10, v13
    v_bfe_u32 v2, v0, 2, 2
    v_lshl_add_u32 v13, v2, 4, v13
    v_bfe_u32 v2, v0, 1, 1
    v_lshl_add_u32 v13, v2, 3, v13
    v_xor_b32 v14, 128, v13
    s_add_u32 s11, s11, 2048
    v_add_u32 v13, s11, v13
    v_add_u32 v14, s11, v14
    v_lshrrev_b32 v220, 3, v0
    v_and_b32 v221, 7, v0
    v_mul_u32_u24 v220, 3584, v220
    v_lshl_add_u32 v220, v221, 4, v220
    v_add_u32 v221, 27648, v220
    s_lshl_b32 s25, s7, 6
    s_lshl_b32 s28, s3, 4
    s_add_u32 s25, s25, s28
    s_mul_i32 s25, s25, 3584
    s_lshl_b32 s28, s6, 7
    s_add_u32 s25, s25, s28
    s_cmp_lt_u32 s6, 28
    s_cselect_b32 s25, s25, 2146435072
    s_lshl_b32 s28, s3, 11
    s_waitcnt vmcnt(14)
    v_dot2_f32_bf16 v72, v16, v161, 0
    v_dot2_f32_bf16 v76, v16, v16, 0
    v_dot2_f32_bf16 v73, v17, v161, 0
    v_dot2_f32_bf16 v77, v17, v17, 0
    v_dot2_f32_bf16 v72, v18, v161, v72
    v_dot2_f32_bf16 v76, v18, v18, v76
    v_dot2_f32_bf16 v73, v19, v161, v73
    v_dot2_f32_bf16 v77, v19, v19, v77
    s_waitcnt vmcnt(13)
    v_dot2_f32_bf16 v74, v20, v161, 0
    s_add_u32 m0, s83, 0
    s_nop 0
    buffer_load_dwordx4 v180, s[52:55], s68 offen offset:0 lds
    v_dot2_f32_bf16 v78, v20, v20, 0
    v_dot2_f32_bf16 v75, v21, v161, 0
    v_dot2_f32_bf16 v79, v21, v21, 0
    v_dot2_f32_bf16 v74, v22, v161, v74
    v_dot2_f32_bf16 v78, v22, v22, v78
    v_dot2_f32_bf16 v75, v23, v161, v75
    v_dot2_f32_bf16 v79, v23, v23, v79
    buffer_load_dwordx4 v180, s[52:55], s69 offen offset:1024 lds
    s_waitcnt vmcnt(14)
    v_dot2_f32_bf16 v72, v24, v161, v72
    v_dot2_f32_bf16 v76, v24, v24, v76
    v_dot2_f32_bf16 v73, v25, v161, v73
    v_dot2_f32_bf16 v77, v25, v25, v77
    v_dot2_f32_bf16 v72, v26, v161, v72
    v_dot2_f32_bf16 v76, v26, v26, v76
    v_dot2_f32_bf16 v73, v27, v161, v73
    v_dot2_f32_bf16 v77, v27, v27, v77
    s_waitcnt vmcnt(13)
    v_dot2_f32_bf16 v74, v28, v161, v74
    buffer_load_dwordx4 v180, s[52:55], s70 offen offset:2048 lds
    v_dot2_f32_bf16 v78, v28, v28, v78
    v_dot2_f32_bf16 v75, v29, v161, v75
    v_dot2_f32_bf16 v79, v29, v29, v79
    v_dot2_f32_bf16 v74, v30, v161, v74
    v_dot2_f32_bf16 v78, v30, v30, v78
    v_dot2_f32_bf16 v75, v31, v161, v75
    v_dot2_f32_bf16 v79, v31, v31, v79
    buffer_load_dwordx4 v180, s[52:55], s71 offen offset:3072 lds
    s_waitcnt vmcnt(14)
    v_dot2_f32_bf16 v72, v32, v161, v72
    v_dot2_f32_bf16 v76, v32, v32, v76
    v_dot2_f32_bf16 v73, v33, v161, v73
    v_dot2_f32_bf16 v77, v33, v33, v77
    v_dot2_f32_bf16 v72, v34, v161, v72
    v_dot2_f32_bf16 v76, v34, v34, v76
    v_dot2_f32_bf16 v73, v35, v161, v73
    v_dot2_f32_bf16 v77, v35, v35, v77
    s_waitcnt vmcnt(13)
    v_dot2_f32_bf16 v74, v36, v161, v74
    s_add_u32 m0, s83, 4096
    s_nop 0
    buffer_load_dwordx4 v180, s[52:55], s72 offen offset:0 lds
    v_dot2_f32_bf16 v78, v36, v36, v78
    v_dot2_f32_bf16 v75, v37, v161, v75
    v_dot2_f32_bf16 v79, v37, v37, v79
    v_dot2_f32_bf16 v74, v38, v161, v74
    v_dot2_f32_bf16 v78, v38, v38, v78
    v_dot2_f32_bf16 v75, v39, v161, v75
    v_dot2_f32_bf16 v79, v39, v39, v79
    buffer_load_dwordx4 v180, s[52:55], s73 offen offset:1024 lds
    s_waitcnt vmcnt(14)
    v_dot2_f32_bf16 v72, v40, v161, v72
    v_dot2_f32_bf16 v76, v40, v40, v76
    v_dot2_f32_bf16 v73, v41, v161, v73
    v_dot2_f32_bf16 v77, v41, v41, v77
    v_dot2_f32_bf16 v72, v42, v161, v72
    v_dot2_f32_bf16 v76, v42, v42, v76
    v_dot2_f32_bf16 v73, v43, v161, v73
    v_dot2_f32_bf16 v77, v43, v43, v77
    s_waitcnt vmcnt(13)
    v_dot2_f32_bf16 v74, v44, v161, v74
    buffer_load_dwordx4 v180, s[52:55], s74 offen offset:2048 lds
    v_dot2_f32_bf16 v78, v44, v44, v78
    v_dot2_f32_bf16 v75, v45, v161, v75
    v_dot2_f32_bf16 v79, v45, v45, v79
    v_dot2_f32_bf16 v74, v46, v161, v74
    v_dot2_f32_bf16 v78, v46, v46, v78
    v_dot2_f32_bf16 v75, v47, v161, v75
    v_dot2_f32_bf16 v79, v47, v47, v79
    s_add_u32 m0, s83, 28672
    s_nop 0
    buffer_load_dwordx4 v180, s[52:55], s75 offen offset:0 lds
    s_waitcnt vmcnt(14)
    v_dot2_f32_bf16 v72, v48, v161, v72
    v_dot2_f32_bf16 v76, v48, v48, v76
    v_dot2_f32_bf16 v73, v49, v161, v73
    v_dot2_f32_bf16 v77, v49, v49, v77
    v_dot2_f32_bf16 v72, v50, v161, v72
    v_dot2_f32_bf16 v76, v50, v50, v76
    v_dot2_f32_bf16 v73, v51, v161, v73
    v_dot2_f32_bf16 v77, v51, v51, v77
    s_waitcnt vmcnt(13)
    v_dot2_f32_bf16 v74, v52, v161, v74
    buffer_load_dwordx4 v180, s[52:55], s76 offen offset:1024 lds
    v_dot2_f32_bf16 v78, v52, v52, v78
    v_dot2_f32_bf16 v75, v53, v161, v75
    v_dot2_f32_bf16 v79, v53, v53, v79
    v_dot2_f32_bf16 v74, v54, v161, v74
    v_dot2_f32_bf16 v78, v54, v54, v78
    v_dot2_f32_bf16 v75, v55, v161, v75
    v_dot2_f32_bf16 v79, v55, v55, v79
    buffer_load_dwordx4 v180, s[52:55], s77 offen offset:2048 lds
    s_waitcnt vmcnt(13)
    v_dot2_f32_bf16 v72, v56, v161, v72
    v_dot2_f32_bf16 v76, v56, v56, v76
    v_dot2_f32_bf16 v73, v57, v161, v73
    v_dot2_f32_bf16 v77, v57, v57, v77
    v_dot2_f32_bf16 v72, v58, v161, v72
    v_dot2_f32_bf16 v76, v58, v58, v76
    v_dot2_f32_bf16 v73, v59, v161, v73
    v_dot2_f32_bf16 v77, v59, v59, v77
    s_waitcnt vmcnt(12)
    v_dot2_f32_bf16 v74, v60, v161, v74
    buffer_load_dwordx4 v180, s[52:55], s78 offen offset:3072 lds
    v_dot2_f32_bf16 v78, v60, v60, v78
    v_dot2_f32_bf16 v75, v61, v161, v75
    v_dot2_f32_bf16 v79, v61, v61, v79
    v_dot2_f32_bf16 v74, v62, v161, v74
    v_dot2_f32_bf16 v78, v62, v62, v78
    v_dot2_f32_bf16 v75, v63, v161, v75
    v_dot2_f32_bf16 v79, v63, v63, v79
    s_add_u32 m0, s83, 32768
    s_nop 0
    buffer_load_dwordx4 v180, s[52:55], s79 offen offset:0 lds
    s_waitcnt vmcnt(13)
    v_dot2_f32_bf16 v72, v64, v161, v72
    v_dot2_f32_bf16 v76, v64, v64, v76
    v_dot2_f32_bf16 v73, v65, v161, v73
    v_dot2_f32_bf16 v77, v65, v65, v77
    v_dot2_f32_bf16 v72, v66, v161, v72
    v_dot2_f32_bf16 v76, v66, v66, v76
    v_dot2_f32_bf16 v73, v67, v161, v73
    v_dot2_f32_bf16 v77, v67, v67, v77
    s_waitcnt vmcnt(12)
    v_dot2_f32_bf16 v74, v68, v161, v74
    buffer_load_dwordx4 v180, s[52:55], s80 offen offset:1024 lds
    v_dot2_f32_bf16 v78, v68, v68, v78
    v_dot2_f32_bf16 v75, v69, v161, v75
    v_dot2_f32_bf16 v79, v69, v69, v79
    v_dot2_f32_bf16 v74, v70, v161, v74
    v_dot2_f32_bf16 v78, v70, v70, v78
    v_dot2_f32_bf16 v75, v71, v161, v75
    v_dot2_f32_bf16 v79, v71, v71, v79
    buffer_load_dwordx4 v180, s[52:55], s81 offen offset:2048 lds
    v_mov_b32 v184, 0
    v_mov_b32 v185, 0
    v_mov_b32 v186, 0
    v_mov_b32 v187, 0
    buffer_store_dwordx4 v[184:187], v1, s[40:43], s16 offen sc1
    v_add_f32 v72, v72, v73
    v_add_f32 v76, v76, v77
    v_add_f32 v74, v74, v75
    v_add_f32 v78, v78, v79
    v_add_f32_dpp v72, v72, v72 quad_perm:[1,0,3,2] row_mask:0xf bank_mask:0xf
    v_add_f32_dpp v76, v76, v76 quad_perm:[1,0,3,2] row_mask:0xf bank_mask:0xf
    v_add_f32_dpp v74, v74, v74 quad_perm:[1,0,3,2] row_mask:0xf bank_mask:0xf
    v_add_f32_dpp v78, v78, v78 quad_perm:[1,0,3,2] row_mask:0xf bank_mask:0xf
    v_add_f32_dpp v72, v72, v72 quad_perm:[2,3,0,1] row_mask:0xf bank_mask:0xf
    v_add_f32_dpp v76, v76, v76 quad_perm:[2,3,0,1] row_mask:0xf bank_mask:0xf
    v_add_f32_dpp v74, v74, v74 quad_perm:[2,3,0,1] row_mask:0xf bank_mask:0xf
    v_add_f32_dpp v78, v78, v78 quad_perm:[2,3,0,1] row_mask:0xf bank_mask:0xf
    v_add_f32_dpp v72, v72, v72 row_half_mirror row_mask:0xf bank_mask:0xf
    v_add_f32_dpp v76, v76, v76 row_half_mirror row_mask:0xf bank_mask:0xf
    v_add_f32_dpp v74, v74, v74 row_half_mirror row_mask:0xf bank_mask:0xf
    v_add_f32_dpp v78, v78, v78 row_half_mirror row_mask:0xf bank_mask:0xf
    v_mul_f32 v72, 0x3b124925, v72
    v_mul_f32 v76, 0x3b124925, v76
    v_fma_f32 v76, -v72, v72, v76
    v_max_f32 v76, 0, v76
    v_add_f32 v76, 0x3727c5ac, v76
    v_rsq_f32 v162, v76
    s_nop 0
    v_mul_f32_e64 v166, -v72, v162
    v_mul_f32 v74, 0x3b124925, v74
    v_mul_f32 v78, 0x3b124925, v78
    v_fma_f32 v78, -v74, v74, v78
    v_max_f32 v78, 0, v78
    v_add_f32 v78, 0x3727c5ac, v78
    v_rsq_f32 v164, v78
    s_nop 0
    v_mul_f32_e64 v168, -v74, v164
    v_lshlrev_b32 v136, 16, v16
    v_and_b32 v137, v170, v16
    v_lshlrev_b32 v138, 16, v17
    v_and_b32 v139, v170, v17
    v_lshlrev_b32 v140, 16, v18
    v_and_b32 v141, v170, v18
    v_lshlrev_b32 v142, 16, v19
    v_and_b32 v143, v170, v19
    v_pk_fma_f32 v[136:137], v[136:137], v[162:163], v[166:167] op_sel_hi:[1,0,0]
    v_pk_fma_f32 v[138:139], v[138:139], v[162:163], v[166:167] op_sel_hi:[1,0,0]
    v_pk_fma_f32 v[140:141], v[140:141], v[162:163], v[166:167] op_sel_hi:[1,0,0]
    v_pk_fma_f32 v[142:143], v[142:143], v[162:163], v[166:167] op_sel_hi:[1,0,0]
    v_cvt_pk_bf16_f32 v16, v136, v137
    v_cvt_pk_bf16_f32 v17, v138, v139
    v_cvt_pk_bf16_f32 v18, v140, v141
    v_cvt_pk_bf16_f32 v19, v142, v143
    ds_write_b128 v152, v[16:19] offset:0
    v_lshlrev_b32 v144, 16, v20
    v_and_b32 v145, v170, v20
    v_lshlrev_b32 v146, 16, v21
    s_add_u32 m0, s83, 57344
    s_nop 0
    buffer_load_dwordx4 v181, s[52:55], s68 offen offset:0 lds
    v_and_b32 v147, v170, v21
    v_lshlrev_b32 v148, 16, v22
    v_and_b32 v149, v170, v22
    v_lshlrev_b32 v150, 16, v23
    v_and_b32 v151, v170, v23
    v_pk_fma_f32 v[144:145], v[144:145], v[164:165], v[168:169] op_sel_hi:[1,0,0]
    v_pk_fma_f32 v[146:147], v[146:147], v[164:165], v[168:169] op_sel_hi:[1,0,0]
    v_pk_fma_f32 v[148:149], v[148:149], v[164:165], v[168:169] op_sel_hi:[1,0,0]
    v_pk_fma_f32 v[150:151], v[150:151], v[164:165], v[168:169] op_sel_hi:[1,0,0]
    v_cvt_pk_bf16_f32 v20, v144, v145
    v_cvt_pk_bf16_f32 v21, v146, v147
    v_cvt_pk_bf16_f32 v22, v148, v149
    v_cvt_pk_bf16_f32 v23, v150, v151
    ds_write_b128 v153, v[20:23] offset:0
    v_lshlrev_b32 v136, 16, v24
    v_and_b32 v137, v170, v24
    v_lshlrev_b32 v138, 16, v25
    v_and_b32 v139, v170, v25
    v_lshlrev_b32 v140, 16, v26
    buffer_load_dwordx4 v181, s[52:55], s69 offen offset:1024 lds
    v_and_b32 v141, v170, v26
    v_lshlrev_b32 v142, 16, v27
    v_and_b32 v143, v170, v27
    v_pk_fma_f32 v[136:137], v[136:137], v[162:163], v[166:167] op_sel_hi:[1,0,0]
    v_pk_fma_f32 v[138:139], v[138:139], v[162:163], v[166:167] op_sel_hi:[1,0,0]
    v_pk_fma_f32 v[140:141], v[140:141], v[162:163], v[166:167] op_sel_hi:[1,0,0]
    v_pk_fma_f32 v[142:143], v[142:143], v[162:163], v[166:167] op_sel_hi:[1,0,0]
    v_cvt_pk_bf16_f32 v24, v136, v137
    v_cvt_pk_bf16_f32 v25, v138, v139
    v_cvt_pk_bf16_f32 v26, v140, v141
    v_cvt_pk_bf16_f32 v27, v142, v143
    ds_write_b128 v152, v[24:27] offset:8192
    v_lshlrev_b32 v144, 16, v28
    v_and_b32 v145, v170, v28
    v_lshlrev_b32 v146, 16, v29
    v_and_b32 v147, v170, v29
    v_lshlrev_b32 v148, 16, v30
    v_and_b32 v149, v170, v30
    v_lshlrev_b32 v150, 16, v31
    v_and_b32 v151, v170, v31
    buffer_load_dwordx4 v181, s[52:55], s70 offen offset:2048 lds
    v_pk_fma_f32 v[144:145], v[144:145], v[164:165], v[168:169] op_sel_hi:[1,0,0]
    v_pk_fma_f32 v[146:147], v[146:147], v[164:165], v[168:169] op_sel_hi:[1,0,0]
    v_pk_fma_f32 v[148:149], v[148:149], v[164:165], v[168:169] op_sel_hi:[1,0,0]
    v_pk_fma_f32 v[150:151], v[150:151], v[164:165], v[168:169] op_sel_hi:[1,0,0]
    v_cvt_pk_bf16_f32 v28, v144, v145
    v_cvt_pk_bf16_f32 v29, v146, v147
    v_cvt_pk_bf16_f32 v30, v148, v149
    v_cvt_pk_bf16_f32 v31, v150, v151
    ds_write_b128 v153, v[28:31] offset:8192
    s_load_dword s50, s[32:33], 0x0
    v_lshlrev_b32 v136, 16, v32
    v_and_b32 v137, v170, v32
    v_lshlrev_b32 v138, 16, v33
    v_and_b32 v139, v170, v33
    v_lshlrev_b32 v140, 16, v34
    v_and_b32 v141, v170, v34
    v_lshlrev_b32 v142, 16, v35
    v_and_b32 v143, v170, v35
    v_pk_fma_f32 v[136:137], v[136:137], v[162:163], v[166:167] op_sel_hi:[1,0,0]
    buffer_load_dwordx4 v181, s[52:55], s71 offen offset:3072 lds
    v_pk_fma_f32 v[138:139], v[138:139], v[162:163], v[166:167] op_sel_hi:[1,0,0]
    v_pk_fma_f32 v[140:141], v[140:141], v[162:163], v[166:167] op_sel_hi:[1,0,0]
    v_pk_fma_f32 v[142:143], v[142:143], v[162:163], v[166:167] op_sel_hi:[1,0,0]
    v_cvt_pk_bf16_f32 v32, v136, v137
    v_cvt_pk_bf16_f32 v33, v138, v139
    v_cvt_pk_bf16_f32 v34, v140, v141
    v_cvt_pk_bf16_f32 v35, v142, v143
    ds_write_b128 v152, v[32:35] offset:16384
    v_lshlrev_b32 v144, 16, v36
    v_and_b32 v145, v170, v36
    v_lshlrev_b32 v146, 16, v37
    v_and_b32 v147, v170, v37
    v_lshlrev_b32 v148, 16, v38
    v_and_b32 v149, v170, v38
    v_lshlrev_b32 v150, 16, v39
    v_and_b32 v151, v170, v39
    v_pk_fma_f32 v[144:145], v[144:145], v[164:165], v[168:169] op_sel_hi:[1,0,0]
    v_pk_fma_f32 v[146:147], v[146:147], v[164:165], v[168:169] op_sel_hi:[1,0,0]
    v_pk_fma_f32 v[148:149], v[148:149], v[164:165], v[168:169] op_sel_hi:[1,0,0]
    v_pk_fma_f32 v[150:151], v[150:151], v[164:165], v[168:169] op_sel_hi:[1,0,0]
    s_add_u32 m0, s83, 61440
    s_nop 0
    buffer_load_dwordx4 v181, s[52:55], s72 offen offset:0 lds
    v_cvt_pk_bf16_f32 v36, v144, v145
    v_cvt_pk_bf16_f32 v37, v146, v147
    v_cvt_pk_bf16_f32 v38, v148, v149
    v_cvt_pk_bf16_f32 v39, v150, v151
    ds_write_b128 v153, v[36:39] offset:16384
    v_lshlrev_b32 v136, 16, v40
    v_and_b32 v137, v170, v40
    v_lshlrev_b32 v138, 16, v41
    v_and_b32 v139, v170, v41
    v_lshlrev_b32 v140, 16, v42
    v_and_b32 v141, v170, v42
    v_lshlrev_b32 v142, 16, v43
    v_and_b32 v143, v170, v43
    v_pk_fma_f32 v[136:137], v[136:137], v[162:163], v[166:167] op_sel_hi:[1,0,0]
    v_pk_fma_f32 v[138:139], v[138:139], v[162:163], v[166:167] op_sel_hi:[1,0,0]
    v_pk_fma_f32 v[140:141], v[140:141], v[162:163], v[166:167] op_sel_hi:[1,0,0]
    v_pk_fma_f32 v[142:143], v[142:143], v[162:163], v[166:167] op_sel_hi:[1,0,0]
    v_cvt_pk_bf16_f32 v40, v136, v137
    v_cvt_pk_bf16_f32 v41, v138, v139
    buffer_load_dwordx4 v181, s[52:55], s73 offen offset:1024 lds
    v_cvt_pk_bf16_f32 v42, v140, v141
    v_cvt_pk_bf16_f32 v43, v142, v143
    ds_write_b128 v152, v[40:43] offset:24576
    v_lshlrev_b32 v144, 16, v44
    v_and_b32 v145, v170, v44
    v_lshlrev_b32 v146, 16, v45
    v_and_b32 v147, v170, v45
    v_lshlrev_b32 v148, 16, v46
    v_and_b32 v149, v170, v46
    v_lshlrev_b32 v150, 16, v47
    v_and_b32 v151, v170, v47
    v_pk_fma_f32 v[144:145], v[144:145], v[164:165], v[168:169] op_sel_hi:[1,0,0]
    v_pk_fma_f32 v[146:147], v[146:147], v[164:165], v[168:169] op_sel_hi:[1,0,0]
    v_pk_fma_f32 v[148:149], v[148:149], v[164:165], v[168:169] op_sel_hi:[1,0,0]
    v_pk_fma_f32 v[150:151], v[150:151], v[164:165], v[168:169] op_sel_hi:[1,0,0]
    v_cvt_pk_bf16_f32 v44, v144, v145
    v_cvt_pk_bf16_f32 v45, v146, v147
    v_cvt_pk_bf16_f32 v46, v148, v149
    v_cvt_pk_bf16_f32 v47, v150, v151
    ds_write_b128 v153, v[44:47] offset:24576
    s_waitcnt vmcnt(14)
    s_waitcnt lgkmcnt(0)
    s_barrier
    s_waitcnt lgkmcnt(0)
    s_cmp_lg_u32 s50, 0
    s_cbranch_scc0 L_ep_1
L_epd_2:
    s_mov_b32 s51, s50
    v_mov_b32 v250, s50
    v_mov_b32 v251, s50
    v_mov_b32 v252, s50
    v_mov_b32 v253, s50
    ds_read_b128 a[0:3], v154 offset:0
    ds_read_b64_tr_b16 v[104:105], v158 offset:0
    ds_read_b64_tr_b16 v[106:107], v158 offset:512
    ds_read_b128 a[4:7], v155 offset:0
    ds_read_b64_tr_b16 v[108:109], v158 offset:14336
    ds_read_b64_tr_b16 v[110:111], v158 offset:14848
    ds_read_b128 a[8:11], v156 offset:0
    ds_read_b64_tr_b16 v[112:113], v158 offset:1024
    ds_read_b64_tr_b16 v[114:115], v158 offset:1536
    ds_read_b128 a[12:15], v157 offset:0
    ds_read_b64_tr_b16 v[116:117], v158 offset:15360
    ds_read_b64_tr_b16 v[118:119], v158 offset:15872
    ds_read_b128 a[16:19], v154 offset:8192
    ds_read_b64_tr_b16 v[120:121], v158 offset:2048
    ds_read_b64_tr_b16 v[122:123], v158 offset:2560
    ds_read_b128 a[20:23], v155 offset:8192
    ds_read_b64_tr_b16 v[124:125], v158 offset:16384
    ds_read_b64_tr_b16 v[126:127], v158 offset:16896
    s_waitcnt lgkmcnt(15)
    v_mfma_f32_32x32x16_bf16 v[72:87], v[104:107], a[0:3], 0
    buffer_load_dwordx4 v181, s[52:55], s74 offen offset:2048 lds
    v_lshlrev_b32 v136, 16, v48
    v_and_b32 v137, v170, v48
    v_lshlrev_b32 v138, 16, v49
    v_and_b32 v139, v170, v49
    v_lshlrev_b32 v140, 16, v50
    v_and_b32 v141, v170, v50
    v_lshlrev_b32 v142, 16, v51
    v_and_b32 v143, v170, v51
    v_fma_f32 v136, v136, v162, v166
    v_fma_f32 v137, v137, v162, v166
    v_fma_f32 v138, v138, v162, v166
    v_fma_f32 v139, v139, v162, v166
    v_fma_f32 v140, v140, v162, v166
    v_fma_f32 v141, v141, v162, v166
    ds_read_b128 a[24:27], v156 offset:8192
    ds_read_b64_tr_b16 v[128:129], v158 offset:3072
    ds_read_b64_tr_b16 v[130:131], v158 offset:3584
    s_waitcnt lgkmcnt(15)
    v_mfma_f32_32x32x16_bf16 v[72:87], v[108:111], a[4:7], v[72:87]
    s_add_u32 m0, s83, 86016
    s_nop 0
    buffer_load_dwordx4 v181, s[52:55], s75 offen offset:0 lds
    v_fma_f32 v142, v142, v162, v166
    v_fma_f32 v143, v143, v162, v166
    v_cvt_pk_bf16_f32 v48, v136, v137
    v_cvt_pk_bf16_f32 v49, v138, v139
    v_cvt_pk_bf16_f32 v50, v140, v141
    v_cvt_pk_bf16_f32 v51, v142, v143
    ds_write_b128 v152, v[48:51] offset:32768
    v_lshlrev_b32 v144, 16, v52
    v_and_b32 v145, v170, v52
    v_lshlrev_b32 v146, 16, v53
    v_and_b32 v147, v170, v53
    v_lshlrev_b32 v148, 16, v54
    v_and_b32 v149, v170, v54
    ds_read_b128 a[28:31], v157 offset:8192
    ds_read_b64_tr_b16 v[132:133], v158 offset:17408
    ds_read_b64_tr_b16 v[134:135], v158 offset:17920
    s_waitcnt lgkmcnt(15)
    v_mfma_f32_32x32x16_bf16 v[72:87], v[112:115], a[8:11], v[72:87]
    v_lshlrev_b32 v150, 16, v55
    buffer_load_dwordx4 v181, s[52:55], s76 offen offset:1024 lds
    v_and_b32 v151, v170, v55
    v_fma_f32 v144, v144, v164, v168
    v_fma_f32 v145, v145, v164, v168
    v_fma_f32 v146, v146, v164, v168
    v_fma_f32 v147, v147, v164, v168
    v_fma_f32 v148, v148, v164, v168
    v_fma_f32 v149, v149, v164, v168
    v_fma_f32 v150, v150, v164, v168
    v_fma_f32 v151, v151, v164, v168
    v_cvt_pk_bf16_f32 v52, v144, v145
    v_cvt_pk_bf16_f32 v53, v146, v147
    v_cvt_pk_bf16_f32 v54, v148, v149
    v_cvt_pk_bf16_f32 v55, v150, v151
    ds_read_b128 a[32:35], v154 offset:16384
    ds_read_b64_tr_b16 v[104:105], v158 offset:4096
    ds_read_b64_tr_b16 v[106:107], v158 offset:4608
    s_waitcnt lgkmcnt(15)
    v_mfma_f32_32x32x16_bf16 v[72:87], v[116:119], a[12:15], v[72:87]
    ds_write_b128 v153, v[52:55] offset:32768
    buffer_load_dwordx4 v181, s[52:55], s77 offen offset:2048 lds
    v_lshlrev_b32 v136, 16, v56
    v_and_b32 v137, v170, v56
    v_lshlrev_b32 v138, 16, v57
    v_and_b32 v139, v170, v57
    v_lshlrev_b32 v140, 16, v58
    v_and_b32 v141, v170, v58
    v_lshlrev_b32 v142, 16, v59
    v_and_b32 v143, v170, v59
    v_fma_f32 v136, v136, v162, v166
    v_fma_f32 v137, v137, v162, v166
    v_fma_f32 v138, v138, v162, v166
    v_fma_f32 v139, v139, v162, v166
    v_fma_f32 v140, v140, v162, v166
    ds_read_b128 a[36:39], v155 offset:16384
    ds_read_b64_tr_b16 v[108:109], v158 offset:18432
    ds_read_b64_tr_b16 v[110:111], v158 offset:18944
    s_waitcnt lgkmcnt(15)
    v_mfma_f32_32x32x16_bf16 v[72:87], v[120:123], a[16:19], v[72:87]
    v_fma_f32 v141, v141, v162, v166
    v_fma_f32 v142, v142, v162, v166
    buffer_load_dwordx4 v181, s[52:55], s78 offen offset:3072 lds
    v_fma_f32 v143, v143, v162, v166
    v_cvt_pk_bf16_f32 v56, v136, v137
    v_cvt_pk_bf16_f32 v57, v138, v139
    v_cvt_pk_bf16_f32 v58, v140, v141
    v_cvt_pk_bf16_f32 v59, v142, v143
    ds_write_b128 v152, v[56:59] offset:40960
    v_lshlrev_b32 v144, 16, v60
    v_and_b32 v145, v170, v60
    v_lshlrev_b32 v146, 16, v61
    v_and_b32 v147, v170, v61
    v_lshlrev_b32 v148, 16, v62
    v_and_b32 v149, v170, v62
    v_lshlrev_b32 v150, 16, v63
    ds_read_b128 a[40:43], v156 offset:16384
    ds_read_b64_tr_b16 v[112:113], v158 offset:5120
    ds_read_b64_tr_b16 v[114:115], v158 offset:5632
    s_waitcnt lgkmcnt(15)
    v_mfma_f32_32x32x16_bf16 v[72:87], v[124:127], a[20:23], v[72:87]
    v_and_b32 v151, v170, v63
    s_add_u32 m0, s83, 90112
    s_nop 0
    buffer_load_dwordx4 v181, s[52:55], s79 offen offset:0 lds
    v_fma_f32 v144, v144, v164, v168
    v_fma_f32 v145, v145, v164, v168
    v_fma_f32 v146, v146, v164, v168
    v_fma_f32 v147, v147, v164, v168
    v_fma_f32 v148, v148, v164, v168
    v_fma_f32 v149, v149, v164, v168
    v_fma_f32 v150, v150, v164, v168
    v_fma_f32 v151, v151, v164, v168
    v_cvt_pk_bf16_f32 v60, v144, v145
    v_cvt_pk_bf16_f32 v61, v146, v147
    v_cvt_pk_bf16_f32 v62, v148, v149
    v_cvt_pk_bf16_f32 v63, v150, v151
    ds_read_b128 a[44:47], v157 offset:16384
    ds_read_b64_tr_b16 v[116:117], v158 offset:19456
    ds_read_b64_tr_b16 v[118:119], v158 offset:19968
    v_mfma_f32_32x32x16_bf16 v[72:87], v[128:131], a[24:27], v[72:87]
    ds_write_b128 v153, v[60:63] offset:40960
    v_lshlrev_b32 v136, 16, v64
    buffer_load_dwordx4 v181, s[52:55], s80 offen offset:1024 lds
    v_and_b32 v137, v170, v64
    v_lshlrev_b32 v138, 16, v65
    v_and_b32 v139, v170, v65
    v_lshlrev_b32 v140, 16, v66
    v_and_b32 v141, v170, v66
    v_lshlrev_b32 v142, 16, v67
    v_and_b32 v143, v170, v67
    v_fma_f32 v136, v136, v162, v166
    v_fma_f32 v137, v137, v162, v166
    v_fma_f32 v138, v138, v162, v166
    v_fma_f32 v139, v139, v162, v166
    v_fma_f32 v140, v140, v162, v166
    ds_read_b128 a[48:51], v154 offset:24576
    ds_read_b64_tr_b16 v[120:121], v158 offset:6144
    ds_read_b64_tr_b16 v[122:123], v158 offset:6656
    s_waitcnt lgkmcnt(15)
    v_mfma_f32_32x32x16_bf16 v[72:87], v[132:135], a[28:31], v[72:87]
    v_fma_f32 v141, v141, v162, v166
    v_fma_f32 v142, v142, v162, v166
    buffer_load_dwordx4 v181, s[52:55], s81 offen offset:2048 lds
    v_fma_f32 v143, v143, v162, v166
    v_cvt_pk_bf16_f32 v64, v136, v137
    v_cvt_pk_bf16_f32 v65, v138, v139
    v_cvt_pk_bf16_f32 v66, v140, v141
    v_cvt_pk_bf16_f32 v67, v142, v143
    s_barrier
    ds_write_b128 v152, v[64:67] offset:0
    v_lshlrev_b32 v144, 16, v68
    v_and_b32 v145, v170, v68
    v_lshlrev_b32 v146, 16, v69
    v_and_b32 v147, v170, v69
    v_lshlrev_b32 v148, 16, v70
    ds_read_b128 a[52:55], v155 offset:24576
    ds_read_b64_tr_b16 v[124:125], v158 offset:20480
    ds_read_b64_tr_b16 v[126:127], v158 offset:20992
    v_mfma_f32_32x32x16_bf16 v[72:87], v[104:107], a[32:35], v[72:87]
    v_and_b32 v149, v170, v70
    v_lshlrev_b32 v150, 16, v71
    v_and_b32 v151, v170, v71
    v_fma_f32 v144, v144, v164, v168
    v_fma_f32 v145, v145, v164, v168
    v_fma_f32 v146, v146, v164, v168
    v_fma_f32 v147, v147, v164, v168
    v_fma_f32 v148, v148, v164, v168
    v_fma_f32 v149, v149, v164, v168
    v_fma_f32 v150, v150, v164, v168
    v_fma_f32 v151, v151, v164, v168
    v_cvt_pk_bf16_f32 v68, v144, v145
    v_cvt_pk_bf16_f32 v69, v146, v147
    v_cvt_pk_bf16_f32 v70, v148, v149
    v_cvt_pk_bf16_f32 v71, v150, v151
    ds_write_b128 v153, v[68:71] offset:0
    s_waitcnt vmcnt(15)
    s_waitcnt lgkmcnt(0)
    s_barrier
    ds_read_b128 a[56:59], v156 offset:24576
    ds_read_b64_tr_b16 v[128:129], v158 offset:28672
    ds_read_b64_tr_b16 v[130:131], v158 offset:29184
    v_mfma_f32_32x32x16_bf16 v[72:87], v[108:111], a[36:39], v[72:87]
    s_add_u32 m0, s83, 0
    ds_read_b128 a[60:63], v157 offset:24576
    ds_read_b64_tr_b16 v[132:133], v158 offset:43008
    ds_read_b64_tr_b16 v[134:135], v158 offset:43520
    v_mfma_f32_32x32x16_bf16 v[72:87], v[112:115], a[40:43], v[72:87]
    buffer_load_dwordx4 v182, s[52:55], s68 offen offset:0 lds
    ds_read_b128 a[64:67], v154 offset:32768
    ds_read_b64_tr_b16 v[104:105], v158 offset:29696
    ds_read_b64_tr_b16 v[106:107], v158 offset:30208
    v_mfma_f32_32x32x16_bf16 v[72:87], v[116:119], a[44:47], v[72:87]
    buffer_load_dwordx4 v182, s[52:55], s69 offen offset:1024 lds
    ds_read_b128 a[68:71], v155 offset:32768
    ds_read_b64_tr_b16 v[108:109], v158 offset:44032
    ds_read_b64_tr_b16 v[110:111], v158 offset:44544
    v_mfma_f32_32x32x16_bf16 v[72:87], v[120:123], a[48:51], v[72:87]
    buffer_load_dwordx4 v182, s[52:55], s70 offen offset:2048 lds
    ds_read_b128 a[72:75], v156 offset:32768
    ds_read_b64_tr_b16 v[112:113], v158 offset:30720
    ds_read_b64_tr_b16 v[114:115], v158 offset:31232
    v_mfma_f32_32x32x16_bf16 v[72:87], v[124:127], a[52:55], v[72:87]
    buffer_load_dwordx4 v182, s[52:55], s71 offen offset:3072 lds
    ds_read_b128 a[76:79], v157 offset:32768
    ds_read_b64_tr_b16 v[116:117], v158 offset:45056
    ds_read_b64_tr_b16 v[118:119], v158 offset:45568
    s_waitcnt lgkmcnt(15)
    v_mfma_f32_32x32x16_bf16 v[72:87], v[128:131], a[56:59], v[72:87]
    ds_read_b128 a[80:83], v154 offset:40960
    ds_read_b64_tr_b16 v[120:121], v158 offset:31744
    ds_read_b64_tr_b16 v[122:123], v158 offset:32256
    s_waitcnt lgkmcnt(15)
    v_mfma_f32_32x32x16_bf16 v[72:87], v[132:135], a[60:63], v[72:87]
    ds_read_b128 a[84:87], v155 offset:40960
    ds_read_b64_tr_b16 v[124:125], v158 offset:46080
    ds_read_b64_tr_b16 v[126:127], v158 offset:46592
    s_waitcnt lgkmcnt(15)
    v_mfma_f32_32x32x16_bf16 v[72:87], v[104:107], a[64:67], v[72:87]
    s_add_u32 m0, s83, 4096
    ds_read_b128 a[88:91], v156 offset:40960
    ds_read_b64_tr_b16 v[128:129], v158 offset:32768
    ds_read_b64_tr_b16 v[130:131], v158 offset:33280
    s_waitcnt lgkmcnt(15)
    v_mfma_f32_32x32x16_bf16 v[72:87], v[108:111], a[68:71], v[72:87]
    ds_read_b128 a[92:95], v157 offset:40960
    ds_read_b64_tr_b16 v[132:133], v158 offset:47104
    ds_read_b64_tr_b16 v[134:135], v158 offset:47616
    s_waitcnt lgkmcnt(15)
    v_mfma_f32_32x32x16_bf16 v[72:87], v[112:115], a[72:75], v[72:87]
    buffer_load_dwordx4 v182, s[52:55], s72 offen offset:0 lds
    ds_read_b128 a[96:99], v154 offset:0
    ds_read_b64_tr_b16 v[104:105], v158 offset:33792
    ds_read_b64_tr_b16 v[106:107], v158 offset:34304
    s_waitcnt lgkmcnt(15)
    v_mfma_f32_32x32x16_bf16 v[72:87], v[116:119], a[76:79], v[72:87]
    ds_read_b128 a[100:103], v155 offset:0
    ds_read_b64_tr_b16 v[108:109], v158 offset:48128
    ds_read_b64_tr_b16 v[110:111], v158 offset:48640
    s_waitcnt lgkmcnt(15)
    v_mfma_f32_32x32x16_bf16 v[72:87], v[120:123], a[80:83], v[72:87]
    buffer_load_dwordx4 v182, s[52:55], s73 offen offset:1024 lds
    ds_read_b128 a[104:107], v156 offset:0
    ds_read_b64_tr_b16 v[112:113], v158 offset:34816
    ds_read_b64_tr_b16 v[114:115], v158 offset:35328
    s_waitcnt lgkmcnt(15)
    v_mfma_f32_32x32x16_bf16 v[72:87], v[124:127], a[84:87], v[72:87]
    ds_read_b128 a[108:111], v157 offset:0
    ds_read_b64_tr_b16 v[116:117], v158 offset:49152
    ds_read_b64_tr_b16 v[118:119], v158 offset:49664
    s_waitcnt lgkmcnt(15)
    v_mfma_f32_32x32x16_bf16 v[72:87], v[128:131], a[88:91], v[72:87]
    buffer_load_dwordx4 v182, s[52:55], s74 offen offset:2048 lds
    s_waitcnt vmcnt(14)
    s_waitcnt lgkmcnt(0)
    s_barrier
    ds_read_b64_tr_b16 v[120:121], v159 offset:0
    ds_read_b64_tr_b16 v[122:123], v159 offset:512
    v_mfma_f32_32x32x16_bf16 v[72:87], v[132:135], a[92:95], v[72:87]
    s_add_u32 m0, s83, 28672
    ds_read_b64_tr_b16 v[124:125], v159 offset:14336
    ds_read_b64_tr_b16 v[126:127], v159 offset:14848
    v_mfma_f32_32x32x16_bf16 v[72:87], v[104:107], a[96:99], v[72:87]
    buffer_load_dwordx4 v182, s[52:55], s75 offen offset:0 lds
    ds_read_b64_tr_b16 v[128:129], v159 offset:1024
    ds_read_b64_tr_b16 v[130:131], v159 offset:1536
    v_mfma_f32_32x32x16_bf16 v[72:87], v[108:111], a[100:103], v[72:87]
    buffer_load_dwordx4 v182, s[52:55], s76 offen offset:1024 lds
    ds_read_b64_tr_b16 v[132:133], v159 offset:15360
    ds_read_b64_tr_b16 v[134:135], v159 offset:15872
    v_mfma_f32_32x32x16_bf16 v[72:87], v[112:115], a[104:107], v[72:87]
    buffer_load_dwordx4 v182, s[52:55], s77 offen offset:2048 lds
    ds_read_b64_tr_b16 v[104:105], v159 offset:2048
    ds_read_b64_tr_b16 v[106:107], v159 offset:2560
    v_mfma_f32_32x32x16_bf16 v[72:87], v[116:119], a[108:111], v[72:87]
    buffer_load_dwordx4 v182, s[52:55], s78 offen offset:3072 lds
    ds_read_b64_tr_b16 v[108:109], v159 offset:16384
    ds_read_b64_tr_b16 v[110:111], v159 offset:16896
    s_waitcnt lgkmcnt(10)
    v_mfma_f32_32x32x16_bf16 v[88:103], v[120:123], a[0:3], 0
    ds_read_b64_tr_b16 v[112:113], v159 offset:3072
    ds_read_b64_tr_b16 v[114:115], v159 offset:3584
    s_waitcnt lgkmcnt(10)
    v_mfma_f32_32x32x16_bf16 v[88:103], v[124:127], a[4:7], v[88:103]
    s_add_u32 m0, s83, 32768
    ds_read_b64_tr_b16 v[116:117], v159 offset:17408
    ds_read_b64_tr_b16 v[118:119], v159 offset:17920
    s_waitcnt lgkmcnt(10)
    v_mfma_f32_32x32x16_bf16 v[88:103], v[128:131], a[8:11], v[88:103]
    buffer_load_dwordx4 v182, s[52:55], s79 offen offset:0 lds
    buffer_load_dwordx4 v182, s[52:55], s80 offen offset:1024 lds
    ds_read_b64_tr_b16 v[120:121], v159 offset:4096
    ds_read_b64_tr_b16 v[122:123], v159 offset:4608
    s_waitcnt lgkmcnt(10)
    v_mfma_f32_32x32x16_bf16 v[88:103], v[132:135], a[12:15], v[88:103]
    buffer_load_dwordx4 v182, s[52:55], s81 offen offset:2048 lds
    v_cvt_pk_bf16_f32 v136, v72, v73
    ds_read_b64_tr_b16 v[124:125], v159 offset:18432
    ds_read_b64_tr_b16 v[126:127], v159 offset:18944
    s_waitcnt lgkmcnt(10)
    v_mfma_f32_32x32x16_bf16 v[88:103], v[104:107], a[16:19], v[88:103]
    v_cvt_pk_bf16_f32 v137, v74, v75
    v_cvt_pk_bf16_f32 v138, v76, v77
    ds_read_b64_tr_b16 v[128:129], v159 offset:5120
    ds_read_b64_tr_b16 v[130:131], v159 offset:5632
    s_waitcnt lgkmcnt(10)
    v_mfma_f32_32x32x16_bf16 v[88:103], v[108:111], a[20:23], v[88:103]
    v_cvt_pk_bf16_f32 v139, v78, v79
    ds_read_b64_tr_b16 v[132:133], v159 offset:19456
    ds_read_b64_tr_b16 v[134:135], v159 offset:19968
    s_waitcnt lgkmcnt(10)
    v_mfma_f32_32x32x16_bf16 v[88:103], v[112:115], a[24:27], v[88:103]
    buffer_store_dwordx4 v[136:139], v1, s[40:43], s82 offen offset:0 sc1
    v_cvt_pk_bf16_f32 v140, v80, v81
    ds_read_b64_tr_b16 v[104:105], v159 offset:6144
    ds_read_b64_tr_b16 v[106:107], v159 offset:6656
    s_waitcnt lgkmcnt(10)
    v_mfma_f32_32x32x16_bf16 v[88:103], v[116:119], a[28:31], v[88:103]
    v_cvt_pk_bf16_f32 v141, v82, v83
    v_cvt_pk_bf16_f32 v142, v84, v85
    ds_read_b64_tr_b16 v[108:109], v159 offset:20480
    ds_read_b64_tr_b16 v[110:111], v159 offset:20992
    s_waitcnt lgkmcnt(10)
    v_mfma_f32_32x32x16_bf16 v[88:103], v[120:123], a[32:35], v[88:103]
    v_cvt_pk_bf16_f32 v143, v86, v87
    buffer_store_dwordx4 v[140:143], v1, s[40:43], s82 offen offset:1024 sc1
    s_waitcnt vmcnt(16)
    s_waitcnt lgkmcnt(0)
    s_barrier
    ds_read_b64_tr_b16 v[112:113], v159 offset:28672
    ds_read_b64_tr_b16 v[114:115], v159 offset:29184
    v_mfma_f32_32x32x16_bf16 v[88:103], v[124:127], a[36:39], v[88:103]
    ds_read_b64_tr_b16 v[116:117], v159 offset:43008
    ds_read_b64_tr_b16 v[118:119], v159 offset:43520
    v_mfma_f32_32x32x16_bf16 v[88:103], v[128:131], a[40:43], v[88:103]
    ds_read_b64_tr_b16 v[120:121], v159 offset:29696
    ds_read_b64_tr_b16 v[122:123], v159 offset:30208
    v_mfma_f32_32x32x16_bf16 v[88:103], v[132:135], a[44:47], v[88:103]
    ds_read_b64_tr_b16 v[124:125], v159 offset:44032
    ds_read_b64_tr_b16 v[126:127], v159 offset:44544
    v_mfma_f32_32x32x16_bf16 v[88:103], v[104:107], a[48:51], v[88:103]
    ds_read_b64_tr_b16 v[128:129], v159 offset:30720
    ds_read_b64_tr_b16 v[130:131], v159 offset:31232
    v_mfma_f32_32x32x16_bf16 v[88:103], v[108:111], a[52:55], v[88:103]
    ds_read_b64_tr_b16 v[132:133], v159 offset:45056
    ds_read_b64_tr_b16 v[134:135], v159 offset:45568
    s_waitcnt lgkmcnt(10)
    v_mfma_f32_32x32x16_bf16 v[88:103], v[112:115], a[56:59], v[88:103]
    v_and_b32 v2, 31, v0
    v_lshrrev_b32 v3, 5, v0
    ds_read_b64_tr_b16 v[104:105], v159 offset:31744
    ds_read_b64_tr_b16 v[106:107], v159 offset:32256
    s_waitcnt lgkmcnt(10)
    v_mfma_f32_32x32x16_bf16 v[88:103], v[116:119], a[60:63], v[88:103]
    v_lshlrev_b32 v3, 2, v3
    v_sub_u32 v2, v2, v3
    ds_read_b64_tr_b16 v[108:109], v159 offset:46080
    ds_read_b64_tr_b16 v[110:111], v159 offset:46592
    s_waitcnt lgkmcnt(10)
    v_mfma_f32_32x32x16_bf16 v[88:103], v[120:123], a[64:67], v[88:103]
    v_cmp_le_i32 s[68:69], 0, v2
    v_cmp_le_i32 s[70:71], 1, v2
    ds_read_b64_tr_b16 v[112:113], v159 offset:32768
    ds_read_b64_tr_b16 v[114:115], v159 offset:33280
    s_waitcnt lgkmcnt(10)
    v_mfma_f32_32x32x16_bf16 v[88:103], v[124:127], a[68:71], v[88:103]
    v_cmp_le_i32 s[72:73], 2, v2
    v_cmp_le_i32 s[74:75], 3, v2
    ds_read_b64_tr_b16 v[116:117], v159 offset:47104
    ds_read_b64_tr_b16 v[118:119], v159 offset:47616
    s_waitcnt lgkmcnt(10)
    v_mfma_f32_32x32x16_bf16 v[88:103], v[128:131], a[72:75], v[88:103]
    v_cmp_le_i32 s[76:77], 8, v2
    v_cmp_le_i32 s[78:79], 9, v2
    v_cmp_le_i32 s[80:81], 10, v2
    ds_read_b64_tr_b16 v[120:121], v159 offset:33792
    ds_read_b64_tr_b16 v[122:123], v159 offset:34304
    s_waitcnt lgkmcnt(10)
    v_mfma_f32_32x32x16_bf16 v[88:103], v[132:135], a[76:79], v[88:103]
    v_cmp_le_i32 s[82:83], 11, v2
    v_cmp_le_i32 s[84:85], 16, v2
    ds_read_b64_tr_b16 v[124:125], v159 offset:48128
    ds_read_b64_tr_b16 v[126:127], v159 offset:48640
    s_waitcnt lgkmcnt(10)
    v_mfma_f32_32x32x16_bf16 v[88:103], v[104:107], a[80:83], v[88:103]
    v_cmp_le_i32 s[86:87], 17, v2
    v_cmp_le_i32 s[88:89], 18, v2
    ds_read_b64_tr_b16 v[128:129], v159 offset:34816
    ds_read_b64_tr_b16 v[130:131], v159 offset:35328
    s_waitcnt lgkmcnt(10)
    v_mfma_f32_32x32x16_bf16 v[88:103], v[108:111], a[84:87], v[88:103]
    v_cmp_le_i32 s[90:91], 19, v2
    v_cmp_le_i32 s[92:93], 24, v2
    ds_read_b64_tr_b16 v[132:133], v159 offset:49152
    ds_read_b64_tr_b16 v[134:135], v159 offset:49664
    s_waitcnt lgkmcnt(10)
    v_mfma_f32_32x32x16_bf16 v[88:103], v[112:115], a[88:91], v[88:103]
    v_cmp_le_i32 s[94:95], 25, v2
    v_cmp_le_i32 s[96:97], 26, v2
    v_cmp_le_i32 s[98:99], 27, v2
    s_waitcnt vmcnt(9)
    s_waitcnt lgkmcnt(0)
    s_barrier
    ds_read_b64_tr_b16 v[104:105], v158 offset:0
    ds_read_b64_tr_b16 v[106:107], v158 offset:512
    v_mfma_f32_32x32x16_bf16 v[88:103], v[116:119], a[92:95], v[88:103]
    ds_read_b64_tr_b16 v[108:109], v158 offset:14336
    ds_read_b64_tr_b16 v[110:111], v158 offset:14848
    v_mfma_f32_32x32x16_bf16 v[88:103], v[120:123], a[96:99], v[88:103]
    ds_read_b64_tr_b16 v[112:113], v158 offset:1024
    ds_read_b64_tr_b16 v[114:115], v158 offset:1536
    v_mfma_f32_32x32x16_bf16 v[88:103], v[124:127], a[100:103], v[88:103]
    ds_read_b64_tr_b16 v[116:117], v158 offset:15360
    ds_read_b64_tr_b16 v[118:119], v158 offset:15872
    v_mfma_f32_32x32x16_bf16 v[88:103], v[128:131], a[104:107], v[88:103]
    ds_read_b64_tr_b16 v[120:121], v158 offset:2048
    ds_read_b64_tr_b16 v[122:123], v158 offset:2560
    v_mfma_f32_32x32x16_bf16 v[88:103], v[132:135], a[108:111], v[88:103]
    s_waitcnt vmcnt(0)
    s_mov_b64 exec, 0xffff
    buffer_store_dwordx4 v[250:253], v1, s[40:43], s16 offen offset:0 sc1
    s_mov_b64 exec, -1
    ds_read_b64_tr_b16 v[124:125], v158 offset:16384
    ds_read_b64_tr_b16 v[126:127], v158 offset:16896
    s_waitcnt lgkmcnt(10)
    v_mfma_f32_32x32x16_bf16 v[72:87], v[104:107], a[0:3], 0
    ds_read_b64_tr_b16 v[128:129], v158 offset:3072
    ds_read_b64_tr_b16 v[130:131], v158 offset:3584
    s_waitcnt lgkmcnt(10)
    v_mfma_f32_32x32x16_bf16 v[72:87], v[108:111], a[4:7], v[72:87]
    v_cvt_pk_bf16_f32 v144, v88, v89
    ds_read_b64_tr_b16 v[132:133], v158 offset:17408
    ds_read_b64_tr_b16 v[134:135], v158 offset:17920
    s_waitcnt lgkmcnt(10)
    v_mfma_f32_32x32x16_bf16 v[72:87], v[112:115], a[8:11], v[72:87]
    v_cvt_pk_bf16_f32 v145, v90, v91
    ds_read_b64_tr_b16 v[104:105], v158 offset:4096
    ds_read_b64_tr_b16 v[106:107], v158 offset:4608
    s_waitcnt lgkmcnt(10)
    v_mfma_f32_32x32x16_bf16 v[72:87], v[116:119], a[12:15], v[72:87]
    v_cvt_pk_bf16_f32 v146, v92, v93
    ds_read_b64_tr_b16 v[108:109], v158 offset:18432
    ds_read_b64_tr_b16 v[110:111], v158 offset:18944
    s_waitcnt lgkmcnt(10)
    v_mfma_f32_32x32x16_bf16 v[72:87], v[120:123], a[16:19], v[72:87]
    v_cvt_pk_bf16_f32 v147, v94, v95
    buffer_store_dwordx4 v[144:147], v1, s[40:43], vcc_lo offen offset:0 sc1
    ds_read_b64_tr_b16 v[112:113], v158 offset:5120
    ds_read_b64_tr_b16 v[114:115], v158 offset:5632
    s_waitcnt lgkmcnt(10)
    v_mfma_f32_32x32x16_bf16 v[72:87], v[124:127], a[20:23], v[72:87]
    v_cvt_pk_bf16_f32 v148, v96, v97
    ds_read_b64_tr_b16 v[116:117], v158 offset:19456
    ds_read_b64_tr_b16 v[118:119], v158 offset:19968
    s_waitcnt lgkmcnt(10)
    v_mfma_f32_32x32x16_bf16 v[72:87], v[128:131], a[24:27], v[72:87]
    v_cvt_pk_bf16_f32 v149, v98, v99
    ds_read_b64_tr_b16 v[120:121], v158 offset:6144
    ds_read_b64_tr_b16 v[122:123], v158 offset:6656
    s_waitcnt lgkmcnt(10)
    v_mfma_f32_32x32x16_bf16 v[72:87], v[132:135], a[28:31], v[72:87]
    v_cvt_pk_bf16_f32 v150, v100, v101
    ds_read_b64_tr_b16 v[124:125], v158 offset:20480
    ds_read_b64_tr_b16 v[126:127], v158 offset:20992
    s_waitcnt lgkmcnt(10)
    v_mfma_f32_32x32x16_bf16 v[72:87], v[104:107], a[32:35], v[72:87]
    v_cvt_pk_bf16_f32 v151, v102, v103
    buffer_store_dwordx4 v[148:151], v1, s[40:43], vcc_lo offen offset:1024 sc1
    s_waitcnt lgkmcnt(0)
    s_barrier
    ds_read_b64_tr_b16 v[128:129], v158 offset:28672
    ds_read_b64_tr_b16 v[130:131], v158 offset:29184
    v_mfma_f32_32x32x16_bf16 v[72:87], v[108:111], a[36:39], v[72:87]
    ds_read_b64_tr_b16 v[132:133], v158 offset:43008
    ds_read_b64_tr_b16 v[134:135], v158 offset:43520
    v_mfma_f32_32x32x16_bf16 v[72:87], v[112:115], a[40:43], v[72:87]
    ds_read_b64_tr_b16 v[104:105], v158 offset:29696
    ds_read_b64_tr_b16 v[106:107], v158 offset:30208
    v_mfma_f32_32x32x16_bf16 v[72:87], v[116:119], a[44:47], v[72:87]
    ds_read_b64_tr_b16 v[108:109], v158 offset:44032
    ds_read_b64_tr_b16 v[110:111], v158 offset:44544
    v_mfma_f32_32x32x16_bf16 v[72:87], v[120:123], a[48:51], v[72:87]
    ds_read_b64_tr_b16 v[112:113], v158 offset:30720
    ds_read_b64_tr_b16 v[114:115], v158 offset:31232
    v_mfma_f32_32x32x16_bf16 v[72:87], v[124:127], a[52:55], v[72:87]
    ds_read_b64_tr_b16 v[116:117], v158 offset:45056
    ds_read_b64_tr_b16 v[118:119], v158 offset:45568
    s_waitcnt lgkmcnt(10)
    v_mfma_f32_32x32x16_bf16 v[72:87], v[128:131], a[56:59], v[72:87]
    ds_read_b64_tr_b16 v[120:121], v158 offset:31744
    ds_read_b64_tr_b16 v[122:123], v158 offset:32256
    s_waitcnt lgkmcnt(10)
    v_mfma_f32_32x32x16_bf16 v[72:87], v[132:135], a[60:63], v[72:87]
    ds_read_b64_tr_b16 v[124:125], v158 offset:46080
    ds_read_b64_tr_b16 v[126:127], v158 offset:46592
    s_waitcnt lgkmcnt(10)
    v_mfma_f32_32x32x16_bf16 v[72:87], v[104:107], a[64:67], v[72:87]
    ds_read_b64_tr_b16 v[128:129], v158 offset:32768
    ds_read_b64_tr_b16 v[130:131], v158 offset:33280
    s_waitcnt lgkmcnt(10)
    v_mfma_f32_32x32x16_bf16 v[72:87], v[108:111], a[68:71], v[72:87]
    ds_read_b64_tr_b16 v[132:133], v158 offset:47104
    ds_read_b64_tr_b16 v[134:135], v158 offset:47616
    s_waitcnt lgkmcnt(10)
    v_mfma_f32_32x32x16_bf16 v[72:87], v[112:115], a[72:75], v[72:87]
    ds_read_b64_tr_b16 v[104:105], v158 offset:33792
    ds_read_b64_tr_b16 v[106:107], v158 offset:34304
    s_waitcnt lgkmcnt(10)
    v_mfma_f32_32x32x16_bf16 v[72:87], v[116:119], a[76:79], v[72:87]
    ds_read_b64_tr_b16 v[108:109], v158 offset:48128
    ds_read_b64_tr_b16 v[110:111], v158 offset:48640
    s_waitcnt lgkmcnt(10)
    v_mfma_f32_32x32x16_bf16 v[72:87], v[120:123], a[80:83], v[72:87]
    ds_read_b64_tr_b16 v[112:113], v158 offset:34816
    ds_read_b64_tr_b16 v[114:115], v158 offset:35328
    s_waitcnt lgkmcnt(10)
    v_mfma_f32_32x32x16_bf16 v[72:87], v[124:127], a[84:87], v[72:87]
    ds_read_b64_tr_b16 v[116:117], v158 offset:49152
    ds_read_b64_tr_b16 v[118:119], v158 offset:49664
    s_waitcnt lgkmcnt(10)
    v_mfma_f32_32x32x16_bf16 v[72:87], v[128:131], a[88:91], v[72:87]
    s_waitcnt lgkmcnt(8)
    v_mfma_f32_32x32x16_bf16 v[72:87], v[132:135], a[92:95], v[72:87]
    s_waitcnt lgkmcnt(6)
    v_mfma_f32_32x32x16_bf16 v[72:87], v[104:107], a[96:99], v[72:87]
    s_waitcnt lgkmcnt(0)
    s_load_dword s52, s[34:35], s20 offset:0
    s_load_dword s53, s[34:35], s20 offset:16384
    s_load_dword s54, s[34:35], s20 offset:32768
    s_load_dword s55, s[34:35], s21 offset:0
    s_load_dword s56, s[34:35], s21 offset:16384
    s_load_dword s57, s[34:35], s21 offset:32768
    v_mfma_f32_32x32x16_bf16 v[72:87], v[108:111], a[100:103], v[72:87]
    v_mfma_f32_32x32x16_bf16 v[72:87], v[112:115], a[104:107], v[72:87]
    v_mfma_f32_32x32x16_bf16 v[72:87], v[116:119], a[108:111], v[72:87]
    s_waitcnt vmcnt(0)
    s_mov_b64 exec, 0xffff
    buffer_store_dwordx4 v[250:253], v1, s[40:43], s16 offen offset:256 sc1
    s_mov_b64 exec, -1
    s_nop 7
    v_cvt_pk_bf16_f32 v136, v72, v73
    v_cvt_pk_bf16_f32 v137, v74, v75
    v_cvt_pk_bf16_f32 v138, v76, v77
    v_cvt_pk_bf16_f32 v139, v78, v79
    buffer_store_dwordx4 v[136:139], v1, s[40:43], vcc_hi offen offset:0 sc1
    v_cvt_pk_bf16_f32 v140, v80, v81
    v_cvt_pk_bf16_f32 v141, v82, v83
    v_cvt_pk_bf16_f32 v142, v84, v85
    v_cvt_pk_bf16_f32 v143, v86, v87
    buffer_store_dwordx4 v[140:143], v1, s[40:43], vcc_hi offen offset:1024 sc1
    s_mov_b64 s[14:15], s[34:35]
    s_mov_b32 s13, 3
L_poll_3:
    s_waitcnt lgkmcnt(0)
    s_xor_b64 s[52:53], s[52:53], s[50:51]
    s_xor_b64 s[54:55], s[54:55], s[50:51]
    s_or_b64 s[52:53], s[52:53], s[54:55]
    s_xor_b64 s[56:57], s[56:57], s[50:51]
    s_or_b64 s[52:53], s[52:53], s[56:57]
    s_cbranch_scc0 L_pdone_4
    s_cmp_lg_u32 s13, 3
    s_cbranch_scc1 L_poll_3_nf
    s_waitcnt vmcnt(0)
    s_mov_b64 exec, 0xffff
    buffer_store_dwordx4 v[250:253], v1, s[40:43], s16 offen offset:512 sc1
    s_mov_b64 exec, -1
    L_poll_3_nf:
    s_sub_u32 s13, s13, 1
    s_cbranch_scc1 L_pslow_5
    s_sleep 4
    s_add_u32 s14, s14, 64
    s_addc_u32 s15, s15, 0
    s_load_dword s52, s[14:15], s20 offset:0
    s_load_dword s53, s[14:15], s20 offset:16384
    s_load_dword s54, s[14:15], s20 offset:32768
    s_load_dword s55, s[14:15], s21 offset:0
    s_load_dword s56, s[14:15], s21 offset:16384
    s_load_dword s57, s[14:15], s21 offset:32768
    s_branch L_poll_3
L_pdone_4:
    s_add_u32 m0, s17, 114688
    s_nop 0
    buffer_load_dwordx4 v1, s[40:43], s29 offen offset:0 sc1 lds
    buffer_load_dwordx4 v1, s[40:43], s29 offen offset:1024 sc1 lds
    s_add_u32 m0, s17, 118784
    s_nop 0
    buffer_load_dwordx4 v1, s[40:43], s30 offen offset:0 sc1 lds
    buffer_load_dwordx4 v1, s[40:43], s30 offen offset:1024 sc1 lds
    s_add_u32 m0, s17, 122880
    s_nop 0
    buffer_load_dwordx4 v1, s[40:43], s31 offen offset:0 sc1 lds
    buffer_load_dwordx4 v1, s[40:43], s31 offen offset:1024 sc1 lds
    s_load_dword s52, s[34:35], s22 offset:256
    s_load_dword s53, s[34:35], s23 offset:256
    s_load_dword s54, s[34:35], s18 offset:0
    s_load_dword s55, s[34:35], s18 offset:256
    s_waitcnt vmcnt(6)
    s_mov_b64 exec, 0xffff
    buffer_store_dwordx4 v[250:253], v1, s[40:43], s16 offen offset:512 sc1
    s_mov_b64 exec, -1
    v_and_b32 v15, 31, v0
    v_mul_u32_u24 v15, 896, v15
    v_lshrrev_b32 v2, 5, v0
    v_lshl_add_u32 v15, v2, 4, v15
    s_lshl_b32 s11, s6, 1
    s_and_b32 s12, s3, 1
    s_add_u32 s11, s11, s12
    s_mul_i32 s11, s11, 28672
    s_lshl_b32 s12, s7, 7
    s_add_u32 s11, s11, s12
    s_lshr_b32 s12, s3, 1
    s_lshl_b32 s12, s12, 6
    s_add_u32 s11, s11, s12
    s_mov_b64 s[14:15], s[34:35]
    s_mov_b32 s13, 3
L_poll_6:
    s_waitcnt lgkmcnt(0)
    s_xor_b64 s[52:53], s[52:53], s[50:51]
    s_xor_b64 s[54:55], s[54:55], s[50:51]
    s_or_b64 s[52:53], s[52:53], s[54:55]
    s_cbranch_scc0 L_pdone_7
    s_sub_u32 s13, s13, 1
    s_cbranch_scc1 L_pslow_8
    s_sleep 4
    s_add_u32 s14, s14, 64
    s_addc_u32 s15, s15, 0
    s_load_dword s52, s[14:15], s22 offset:256
    s_load_dword s53, s[14:15], s23 offset:256
    s_load_dword s54, s[14:15], s18 offset:0
    s_load_dword s55, s[14:15], s18 offset:256
    s_branch L_poll_6
L_pdone_7:
L_join1:
    buffer_load_dwordx4 v[232:235], v1, s[40:43], s19 offen offset:0 sc1
    buffer_load_dwordx4 v[236:239], v1, s[40:43], s19 offen offset:1024 sc1
    buffer_load_dwordx4 v[240:243], v15, s[36:39], s11 offen offset:0
    buffer_load_dwordx4 v[244:247], v15, s[36:39], s11 offen offset:32
    s_barrier
    s_lshl_b32 s49, s3, 14
    s_lshl_b32 s48, s7, 16
    s_add_u32 s48, s48, s49
    s_add_u32 s48, s48, 21956608
    s_cmp_ge_u32 s7, 7
    s_cselect_b32 s48, 2146435072, s48
    s_add_u32 m0, s49, 0
    s_nop 0
    buffer_load_dwordx4 v1, s[40:43], s48 offen offset:0 sc1 lds
    buffer_load_dwordx4 v1, s[40:43], s48 offen offset:1024 sc1 lds
    buffer_load_dwordx4 v1, s[40:43], s48 offen offset:2048 sc1 lds
    buffer_load_dwordx4 v1, s[40:43], s48 offen offset:3072 sc1 lds
    s_add_u32 s48, s48, 4096
    s_add_u32 m0, s49, 4096
    s_nop 0
    buffer_load_dwordx4 v1, s[40:43], s48 offen offset:0 sc1 lds
    buffer_load_dwordx4 v1, s[40:43], s48 offen offset:1024 sc1 lds
    buffer_load_dwordx4 v1, s[40:43], s48 offen offset:2048 sc1 lds
    buffer_load_dwordx4 v1, s[40:43], s48 offen offset:3072 sc1 lds
    s_add_u32 m0, s28, 86016
    s_nop 0
    buffer_load_dwordx4 v220, s[60:63], s25 offen offset:0 nt lds
    buffer_load_dwordx4 v221, s[60:63], s25 offen offset:1024 nt lds
    s_add_u32 m0, s28, 94208
    s_nop 0
    buffer_load_dwordx4 v220, s[64:67], s25 offen offset:0 nt lds
    buffer_load_dwordx4 v221, s[64:67], s25 offen offset:1024 nt lds
    v_lshrrev_b32 v2, 5, v0
    v_lshlrev_b32 v2, 3, v2
    v_bfe_u32 v3, v0, 2, 2
    v_add_u32 v2, v2, v3
    v_mul_u32_u24 v15, 128, v2
    v_bfe_u32 v2, v0, 4, 1
    v_mul_u32_u24 v2, 8192, v2
    v_add_u32 v15, v15, v2
    v_and_b32 v2, 1, v0
    v_lshl_add_u32 v15, v2, 4, v15
    v_bfe_u32 v2, v0, 1, 1
    v_lshl_add_u32 v15, v2, 3, v15
    s_lshl_b32 s11, s3, 5
    s_add_u32 s11, s11, 86016
    v_add_u32 v15, s11, v15
    s_lshl_b32 s13, s6, 2
    s_add_u32 s13, s13, s3
    s_mul_i32 s0, s13, 28672
    s_lshl_b32 s12, s7, 12
    s_add_u32 s0, s0, s12
    s_add_u32 s0, s0, 17039360
    s_mul_i32 s1, s13, 896
    s_lshl_b32 s12, s7, 7
    s_add_u32 s1, s1, s12
    s_add_u32 s1, s1, 20250624
    s_lshl_b32 s12, s7, 2
    s_max_u32 s12, s12, s6
    s_cmp_lt_u32 s12, 28
    s_cselect_b32 s0, s0, 2146435072
    s_cselect_b32 s1, s1, 2146435072
    v_mov_b32 v208, 0
    v_mov_b32 v209, 0
    v_mov_b32 v210, 0
    v_mov_b32 v211, 0
    s_lshl_b32 s12, s4, 2
    s_add_u32 s12, s12, s3
    s_lshl_b32 s12, s12, 4
    s_add_u32 s12, s12, s5
    s_lshl_b32 s12, s12, 10
    s_add_u32 s12, s12, 23472128
    s_mov_b32 exec_hi, 0xffff
    buffer_store_dwordx4 v[208:211], v1, s[40:43], s12 offen sc1
    s_mov_b32 exec_hi, -1
    s_lshl_b32 s12, s24, 4
    s_add_u32 s12, s12, s9
    s_lshl_b32 s12, s12, 8
    s_add_u32 s12, s12, 24520704
    s_mov_b64 exec, 0xffff
    buffer_store_dwordx4 v[208:211], v1, s[40:43], s12 offen sc1
    s_mov_b64 exec, -1
    s_waitcnt vmcnt(17)
    v_and_b32 v232, v232, v6
    v_and_b32 v233, v233, v6
    s_waitcnt vmcnt(16)
    v_and_b32 v238, v238, v7
    v_and_b32 v239, v239, v7
    s_barrier
    ds_read_b128 v[160:163], v12 offset:0
    ds_read_b128 v[164:167], v12 offset:1024
    ds_read_b128 v[168:171], v12 offset:32768
    ds_read_b128 v[172:175], v12 offset:33792
    ds_read_b128 v[176:179], v12 offset:4096
    ds_read_b128 v[180:183], v12 offset:5120
    s_waitcnt lgkmcnt(5)
    v_mfma_f32_32x32x16_bf16 v[16:31], v[160:163], v[232:235], 0
    ds_read_b128 v[184:187], v12 offset:8192
    ds_read_b128 v[188:191], v12 offset:9216
    s_waitcnt lgkmcnt(6)
    v_mfma_f32_32x32x16_bf16 v[16:31], v[164:167], v[236:239], v[16:31]
    s_waitcnt lgkmcnt(5)
    v_mfma_f32_32x32x16_bf16 v[144:159], v[168:171], v[232:235], 0
    ds_read_b128 v[160:163], v12 offset:12288
    ds_read_b128 v[164:167], v12 offset:13312
    s_waitcnt lgkmcnt(6)
    v_mfma_f32_32x32x16_bf16 v[144:159], v[172:175], v[236:239], v[144:159]
    s_waitcnt lgkmcnt(5)
    v_mfma_f32_32x32x16_bf16 v[32:47], v[176:179], v[232:235], 0
    ds_read_b128 v[168:171], v12 offset:16384
    ds_read_b128 v[172:175], v12 offset:17408
    s_waitcnt lgkmcnt(6)
    v_mfma_f32_32x32x16_bf16 v[32:47], v[180:183], v[236:239], v[32:47]
    s_waitcnt lgkmcnt(5)
    v_mfma_f32_32x32x16_bf16 v[48:63], v[184:187], v[232:235], 0
    ds_read_b128 v[176:179], v12 offset:20480
    ds_read_b128 v[180:183], v12 offset:21504
    s_waitcnt lgkmcnt(6)
    v_mfma_f32_32x32x16_bf16 v[48:63], v[188:191], v[236:239], v[48:63]
    s_waitcnt lgkmcnt(5)
    v_mfma_f32_32x32x16_bf16 v[64:79], v[160:163], v[232:235], 0
    ds_read_b128 v[184:187], v12 offset:24576
    ds_read_b128 v[188:191], v12 offset:25600
    s_cmp_lt_u32 s24, 8
    s_cbranch_scc1 L_fill_9
L_fill_9_r:
    v_cndmask_b32 v16, v16, v144, s[68:69]
    v_cndmask_b32 v17, v17, v145, s[70:71]
    v_cndmask_b32 v18, v18, v146, s[72:73]
    v_cndmask_b32 v19, v19, v147, s[74:75]
    v_cndmask_b32 v20, v20, v148, s[76:77]
    v_cndmask_b32 v21, v21, v149, s[78:79]
    v_cndmask_b32 v22, v22, v150, s[80:81]
    v_cndmask_b32 v23, v23, v151, s[82:83]
    v_cndmask_b32 v24, v24, v152, s[84:85]
    v_cndmask_b32 v25, v25, v153, s[86:87]
    v_cndmask_b32 v26, v26, v154, s[88:89]
    v_cndmask_b32 v27, v27, v155, s[90:91]
    s_waitcnt lgkmcnt(6)
    v_mfma_f32_32x32x16_bf16 v[64:79], v[164:167], v[236:239], v[64:79]
    v_cndmask_b32 v28, v28, v156, s[92:93]
    v_cndmask_b32 v29, v29, v157, s[94:95]
    v_cndmask_b32 v30, v30, v158, s[96:97]
    v_cndmask_b32 v31, v31, v159, s[98:99]
    v_max_f32 v216, v16, v17
    v_max_f32 v217, v18, v19
    v_max_f32 v218, v20, v21
    v_max_f32 v219, v22, v23
    v_max3_f32 v216, v216, v24, v25
    v_max3_f32 v217, v217, v26, v27
    v_max3_f32 v218, v218, v28, v29
    v_max3_f32 v219, v219, v30, v31
    s_waitcnt lgkmcnt(5)
    v_mfma_f32_32x32x16_bf16 v[80:95], v[168:171], v[232:235], 0
    ds_read_b128 v[160:163], v12 offset:28672
    ds_read_b128 v[164:167], v12 offset:29696
    s_cmp_lt_u32 s24, 7
    s_cbranch_scc1 L_mxa_10
    v_max3_f32 v216, v216, v32, v33
    v_max3_f32 v217, v217, v34, v35
    v_max3_f32 v218, v218, v36, v37
    v_max3_f32 v219, v219, v38, v39
L_mxa_10:
    s_waitcnt lgkmcnt(6)
    v_mfma_f32_32x32x16_bf16 v[80:95], v[172:175], v[236:239], v[80:95]
    s_cbranch_scc1 L_mxb_11
    v_max3_f32 v216, v216, v40, v41
    v_max3_f32 v217, v217, v42, v43
    v_max3_f32 v218, v218, v44, v45
    v_max3_f32 v219, v219, v46, v47
L_mxb_11:
    s_waitcnt lgkmcnt(5)
    v_mfma_f32_32x32x16_bf16 v[96:111], v[176:179], v[232:235], 0
    s_cmp_lt_u32 s24, 6
    s_cbranch_scc1 L_mxa_12
    v_max3_f32 v216, v216, v48, v49
    v_max3_f32 v217, v217, v50, v51
    v_max3_f32 v218, v218, v52, v53
    v_max3_f32 v219, v219, v54, v55
L_mxa_12:
    s_waitcnt lgkmcnt(4)
    v_mfma_f32_32x32x16_bf16 v[96:111], v[180:183], v[236:239], v[96:111]
    s_cbranch_scc1 L_mxb_13
    v_max3_f32 v216, v216, v56, v57
    v_max3_f32 v217, v217, v58, v59
    v_max3_f32 v218, v218, v60, v61
    v_max3_f32 v219, v219, v62, v63
L_mxb_13:
    s_waitcnt lgkmcnt(3)
    v_mfma_f32_32x32x16_bf16 v[112:127], v[184:187], v[232:235], 0
    s_cmp_lt_u32 s24, 5
    s_cbranch_scc1 L_mxa_14
    v_max3_f32 v216, v216, v64, v65
    v_max3_f32 v217, v217, v66, v67
    v_max3_f32 v218, v218, v68, v69
    v_max3_f32 v219, v219, v70, v71
L_mxa_14:
    s_waitcnt lgkmcnt(2)
    v_mfma_f32_32x32x16_bf16 v[112:127], v[188:191], v[236:239], v[112:127]
    s_cbranch_scc1 L_mxb_15
    v_max3_f32 v216, v216, v72, v73
    v_max3_f32 v217, v217, v74, v75
    v_max3_f32 v218, v218, v76, v77
    v_max3_f32 v219, v219, v78, v79
L_mxb_15:
    s_waitcnt lgkmcnt(1)
    v_mfma_f32_32x32x16_bf16 v[128:143], v[160:163], v[232:235], 0
    s_cmp_lt_u32 s24, 4
    s_cbranch_scc1 L_mxa_16
    v_max3_f32 v216, v216, v80, v81
    v_max3_f32 v217, v217, v82, v83
    v_max3_f32 v218, v218, v84, v85
    v_max3_f32 v219, v219, v86, v87
L_mxa_16:
    s_waitcnt lgkmcnt(0)
    v_mfma_f32_32x32x16_bf16 v[128:143], v[164:167], v[236:239], v[128:143]
    s_cbranch_scc1 L_mxb_17
    v_max3_f32 v216, v216, v88, v89
    v_max3_f32 v217, v217, v90, v91
    v_max3_f32 v218, v218, v92, v93
    v_max3_f32 v219, v219, v94, v95
L_mxb_17:
    s_load_dword s52, s[34:35], s20 offset:512
    s_load_dword s53, s[34:35], s20 offset:16896
    s_load_dword s54, s[34:35], s20 offset:33280
    s_load_dword s55, s[34:35], s21 offset:512
    s_load_dword s56, s[34:35], s21 offset:16896
    s_load_dword s57, s[34:35], s21 offset:33280
    s_cmp_lt_u32 s24, 3
    s_cbranch_scc1 L_mxa_18
    v_max3_f32 v216, v216, v96, v97
    v_max3_f32 v217, v217, v98, v99
    v_max3_f32 v218, v218, v100, v101
    v_max3_f32 v219, v219, v102, v103
L_mxa_18:
    s_cbranch_scc1 L_mxb_19
    v_max3_f32 v216, v216, v104, v105
    v_max3_f32 v217, v217, v106, v107
    v_max3_f32 v218, v218, v108, v109
    v_max3_f32 v219, v219, v110, v111
L_mxb_19:
    s_cmp_lt_u32 s24, 2
    s_cbranch_scc1 L_mxa_20
    v_max3_f32 v216, v216, v112, v113
    v_max3_f32 v217, v217, v114, v115
    v_max3_f32 v218, v218, v116, v117
    v_max3_f32 v219, v219, v118, v119
L_mxa_20:
    s_cbranch_scc1 L_mxb_21
    v_max3_f32 v216, v216, v120, v121
    v_max3_f32 v217, v217, v122, v123
    v_max3_f32 v218, v218, v124, v125
    v_max3_f32 v219, v219, v126, v127
L_mxb_21:
    s_cmp_lt_u32 s24, 1
    s_cbranch_scc1 L_mxa_22
    v_max3_f32 v216, v216, v128, v129
    v_max3_f32 v217, v217, v130, v131
    v_max3_f32 v218, v218, v132, v133
    v_max3_f32 v219, v219, v134, v135
L_mxa_22:
    s_cbranch_scc1 L_mxb_23
    v_max3_f32 v216, v216, v136, v137
    v_max3_f32 v217, v217, v138, v139
    v_max3_f32 v218, v218, v140, v141
    v_max3_f32 v219, v219, v142, v143
L_mxb_23:
    s_cmp_lt_u32 s24, 7
    s_cbranch_scc1 L_fillr_24
L_fillr_24_r:
    v_max3_f32 v216, v216, v217, v218
    v_max_f32 v216, v216, v219
    v_mov_b32 v217, v216
    v_mov_b32 v146, 0x3e8b97f6
    s_nop 0
    v_permlane32_swap_b32 v216, v217
    v_max_f32 v216, v216, v217
    v_mul_f32 v148, 0xbe8b97f6, v216
    v_pk_fma_f32 v[16:17], v[16:17], v[146:147], v[148:149] op_sel_hi:[1,0,0]
    v_pk_fma_f32 v[18:19], v[18:19], v[146:147], v[148:149] op_sel_hi:[1,0,0]
    v_pk_fma_f32 v[20:21], v[20:21], v[146:147], v[148:149] op_sel_hi:[1,0,0]
    v_pk_fma_f32 v[22:23], v[22:23], v[146:147], v[148:149] op_sel_hi:[1,0,0]
    v_pk_fma_f32 v[24:25], v[24:25], v[146:147], v[148:149] op_sel_hi:[1,0,0]
    v_pk_fma_f32 v[26:27], v[26:27], v[146:147], v[148:149] op_sel_hi:[1,0,0]
    v_pk_fma_f32 v[28:29], v[28:29], v[146:147], v[148:149] op_sel_hi:[1,0,0]
    v_pk_fma_f32 v[30:31], v[30:31], v[146:147], v[148:149] op_sel_hi:[1,0,0]
    s_mov_b64 s[14:15], s[34:35]
    s_mov_b32 s13, 3
L_poll_25:
    s_waitcnt lgkmcnt(0)
    s_xor_b64 s[52:53], s[52:53], s[50:51]
    s_xor_b64 s[54:55], s[54:55], s[50:51]
    s_or_b64 s[52:53], s[52:53], s[54:55]
    s_xor_b64 s[56:57], s[56:57], s[50:51]
    s_or_b64 s[52:53], s[52:53], s[56:57]
    s_cbranch_scc0 L_pdone_26
    s_sub_u32 s13, s13, 1
    s_cbranch_scc1 L_pslow_27
    s_sleep 4
    s_add_u32 s14, s14, 64
    s_addc_u32 s15, s15, 0
    s_load_dword s52, s[14:15], s20 offset:512
    s_load_dword s53, s[14:15], s20 offset:16896
    s_load_dword s54, s[14:15], s20 offset:33280
    s_load_dword s55, s[14:15], s21 offset:512
    s_load_dword s56, s[14:15], s21 offset:16896
    s_load_dword s57, s[14:15], s21 offset:33280
    s_branch L_poll_25
L_pdone_26:
    s_add_u32 m0, s17, 116736
    s_add_u32 s13, s29, 28672
    buffer_load_dwordx4 v4, s[40:43], s13 offen offset:0 sc1 lds
    buffer_load_dwordx4 v5, s[40:43], s13 offen offset:1024 sc1 lds
    s_add_u32 m0, s17, 120832
    s_add_u32 s13, s30, 28672
    buffer_load_dwordx4 v4, s[40:43], s13 offen offset:0 sc1 lds
    buffer_load_dwordx4 v5, s[40:43], s13 offen offset:1024 sc1 lds
    s_add_u32 m0, s17, 124928
    s_add_u32 s13, s31, 28672
    buffer_load_dwordx4 v4, s[40:43], s13 offen offset:0 sc1 lds
    buffer_load_dwordx4 v5, s[40:43], s13 offen offset:1024 sc1 lds
    s_mul_i32 s31, s3, 7168
    s_mul_i32 s30, s5, 200704
    s_add_u32 s30, s30, s31
    s_add_u32 s30, s30, 17039360
    s_mul_i32 s23, s5, 7
    s_lshr_b32 s23, s23, 2
    s_min_u32 s23, s23, 25
    s_mul_i32 s23, s23, 7
    s_mul_i32 s11, s3, 7
    s_lshr_b32 s11, s11, 2
    s_min_u32 s11, s11, 4
    s_add_u32 s23, s23, s11
    s_lshl_b32 s23, s23, 8
    s_add_u32 s23, s23, 24782848
    s_mul_i32 s22, s3, 1792
    s_add_u32 s22, s22, 24848384
    s_load_dword s52, s[34:35], s22 offset:0
    s_load_dword s53, s[34:35], s22 offset:256
    s_load_dword s54, s[34:35], s22 offset:512
    s_load_dword s55, s[34:35], s22 offset:768
    s_load_dword s56, s[34:35], s22 offset:1024
    s_load_dword s57, s[34:35], s22 offset:1280
    s_load_dword s58, s[34:35], s22 offset:1536
    s_load_dword s59, s[34:35], s22 offset:1536
    v_exp_f32 v16, v16
    v_exp_f32 v17, v17
    s_add_u32 s48, s48, 4096
    s_add_u32 m0, s49, 8192
    s_nop 0
    buffer_load_dwordx4 v1, s[40:43], s48 offen offset:0 sc1 lds
    v_pk_fma_f32 v[32:33], v[32:33], v[146:147], v[148:149] op_sel_hi:[1,0,0]
    v_exp_f32 v18, v18
    v_exp_f32 v19, v19
    v_pk_fma_f32 v[34:35], v[34:35], v[146:147], v[148:149] op_sel_hi:[1,0,0]
    buffer_load_dwordx4 v1, s[40:43], s48 offen offset:1024 sc1 lds
    v_exp_f32 v20, v20
    v_exp_f32 v21, v21
    v_pk_fma_f32 v[36:37], v[36:37], v[146:147], v[148:149] op_sel_hi:[1,0,0]
    v_exp_f32 v22, v22
    buffer_load_dwordx4 v1, s[40:43], s48 offen offset:2048 sc1 lds
    v_exp_f32 v23, v23
    v_pk_fma_f32 v[38:39], v[38:39], v[146:147], v[148:149] op_sel_hi:[1,0,0]
    v_exp_f32 v24, v24
    v_exp_f32 v25, v25
    buffer_load_dwordx4 v1, s[40:43], s48 offen offset:3072 sc1 lds
    v_pk_fma_f32 v[40:41], v[40:41], v[146:147], v[148:149] op_sel_hi:[1,0,0]
    v_exp_f32 v26, v26
    v_exp_f32 v27, v27
    v_pk_fma_f32 v[42:43], v[42:43], v[146:147], v[148:149] op_sel_hi:[1,0,0]
    s_add_u32 s48, s48, 4096
    s_add_u32 m0, s49, 12288
    s_nop 0
    buffer_load_dwordx4 v1, s[40:43], s48 offen offset:0 sc1 lds
    v_exp_f32 v28, v28
    v_exp_f32 v29, v29
    v_pk_fma_f32 v[44:45], v[44:45], v[146:147], v[148:149] op_sel_hi:[1,0,0]
    v_exp_f32 v30, v30
    v_exp_f32 v31, v31
    v_pk_fma_f32 v[46:47], v[46:47], v[146:147], v[148:149] op_sel_hi:[1,0,0]
    v_exp_f32 v32, v32
    v_pk_fma_f32 v[48:49], v[48:49], v[146:147], v[148:149] op_sel_hi:[1,0,0]
    v_pk_fma_f32 v[50:51], v[50:51], v[146:147], v[148:149] op_sel_hi:[1,0,0]
    v_exp_f32 v33, v33
    buffer_load_dwordx4 v1, s[40:43], s48 offen offset:1024 sc1 lds
    v_pk_fma_f32 v[52:53], v[52:53], v[146:147], v[148:149] op_sel_hi:[1,0,0]
    v_pk_fma_f32 v[54:55], v[54:55], v[146:147], v[148:149] op_sel_hi:[1,0,0]
    v_exp_f32 v34, v34
    v_pk_fma_f32 v[56:57], v[56:57], v[146:147], v[148:149] op_sel_hi:[1,0,0]
    v_pk_fma_f32 v[58:59], v[58:59], v[146:147], v[148:149] op_sel_hi:[1,0,0]
    v_exp_f32 v35, v35
    v_pk_fma_f32 v[60:61], v[60:61], v[146:147], v[148:149] op_sel_hi:[1,0,0]
    v_pk_fma_f32 v[62:63], v[62:63], v[146:147], v[148:149] op_sel_hi:[1,0,0]
    v_exp_f32 v36, v36
    v_cvt_pk_bf16_f32 v192, v16, v17
    v_cvt_pk_bf16_f32 v193, v18, v19
    v_exp_f32 v37, v37
    v_cvt_pk_bf16_f32 v194, v20, v21
    buffer_load_dwordx4 v1, s[40:43], s48 offen offset:2048 sc1 lds
    v_cvt_pk_bf16_f32 v195, v22, v23
    v_exp_f32 v38, v38
    v_cvt_pk_bf16_f32 v196, v24, v25
    v_cvt_pk_bf16_f32 v197, v26, v27
    v_exp_f32 v39, v39
    v_cvt_pk_bf16_f32 v198, v28, v29
    v_cvt_pk_bf16_f32 v199, v30, v31
    v_exp_f32 v40, v40
    v_and_b32 v200, v192, v224
    v_bfi_b32 v192, v224, 0, v192
    v_exp_f32 v41, v41
    v_and_b32 v201, v193, v225
    v_bfi_b32 v193, v225, 0, v193
    v_exp_f32 v42, v42
    buffer_load_dwordx4 v1, s[40:43], s48 offen offset:3072 sc1 lds
    v_and_b32 v202, v194, v226
    v_bfi_b32 v194, v226, 0, v194
    v_exp_f32 v43, v43
    v_and_b32 v203, v195, v227
    v_bfi_b32 v195, v227, 0, v195
    v_exp_f32 v44, v44
    v_and_b32 v204, v196, v228
    v_bfi_b32 v196, v228, 0, v196
    v_exp_f32 v45, v45
    v_and_b32 v205, v197, v229
    v_bfi_b32 v197, v229, 0, v197
    v_exp_f32 v46, v46
    v_and_b32 v206, v198, v230
    v_bfi_b32 v198, v230, 0, v198
    v_exp_f32 v47, v47
    v_and_b32 v207, v199, v231
    v_bfi_b32 v199, v231, 0, v199
    s_mov_b64 s[14:15], s[34:35]
    s_mov_b32 s13, 3
L_poll_28:
    s_waitcnt lgkmcnt(0)
    s_xor_b64 s[52:53], s[52:53], s[50:51]
    s_xor_b64 s[54:55], s[54:55], s[50:51]
    s_or_b64 s[52:53], s[52:53], s[54:55]
    s_xor_b64 s[56:57], s[56:57], s[50:51]
    s_or_b64 s[52:53], s[52:53], s[56:57]
    s_xor_b64 s[58:59], s[58:59], s[50:51]
    s_or_b64 s[52:53], s[52:53], s[58:59]
    s_cbranch_scc0 L_pdone_29
    s_sub_u32 s13, s13, 1
    s_cbranch_scc1 L_pslow_30
    s_sleep 4
    s_add_u32 s14, s14, 64
    s_addc_u32 s15, s15, 0
    s_load_dword s52, s[14:15], s22 offset:0
    s_load_dword s53, s[14:15], s22 offset:256
    s_load_dword s54, s[14:15], s22 offset:512
    s_load_dword s55, s[14:15], s22 offset:768
    s_load_dword s56, s[14:15], s22 offset:1024
    s_load_dword s57, s[14:15], s22 offset:1280
    s_load_dword s58, s[14:15], s22 offset:1536
    s_load_dword s59, s[14:15], s22 offset:1536
    s_branch L_poll_28
L_pdone_29:
    v_exp_f32 v48, v48
    v_pk_fma_f32 v[64:65], v[64:65], v[146:147], v[148:149] op_sel_hi:[1,0,0]
    v_exp_f32 v49, v49
    s_mul_i32 s48, s7, 229376
    s_mul_i32 s49, s3, 57344
    s_add_u32 s48, s48, s49
    s_add_u32 s48, s48, 20350976
    s_cmp_ge_u32 s7, 7
    s_cselect_b32 s48, 2146435072, s48
    buffer_load_dwordx4 a[0:3], v248, s[40:43], s48 offen sc1
    v_pk_fma_f32 v[66:67], v[66:67], v[146:147], v[148:149] op_sel_hi:[1,0,0]
    v_exp_f32 v50, v50
    v_pk_fma_f32 v[68:69], v[68:69], v[146:147], v[148:149] op_sel_hi:[1,0,0]
    v_exp_f32 v51, v51
    v_pk_fma_f32 v[70:71], v[70:71], v[146:147], v[148:149] op_sel_hi:[1,0,0]
    buffer_load_dwordx4 a[4:7], v249, s[40:43], s48 offen sc1
    v_exp_f32 v52, v52
    v_pk_fma_f32 v[72:73], v[72:73], v[146:147], v[148:149] op_sel_hi:[1,0,0]
    v_exp_f32 v53, v53
    v_pk_fma_f32 v[74:75], v[74:75], v[146:147], v[148:149] op_sel_hi:[1,0,0]
    v_exp_f32 v54, v54
    s_add_u32 s48, s48, 14336
    buffer_load_dwordx4 a[8:11], v248, s[40:43], s48 offen sc1
    v_pk_fma_f32 v[76:77], v[76:77], v[146:147], v[148:149] op_sel_hi:[1,0,0]
    v_exp_f32 v55, v55
    v_pk_fma_f32 v[78:79], v[78:79], v[146:147], v[148:149] op_sel_hi:[1,0,0]
    v_exp_f32 v56, v56
    v_cvt_pk_bf16_f32 v32, v32, v33
    v_exp_f32 v57, v57
    buffer_load_dwordx4 a[12:15], v249, s[40:43], s48 offen sc1
    v_cvt_pk_bf16_f32 v33, v34, v35
    v_exp_f32 v58, v58
    v_cvt_pk_bf16_f32 v34, v36, v37
    v_exp_f32 v59, v59
    v_cvt_pk_bf16_f32 v35, v38, v39
    s_add_u32 s48, s48, 14336
    buffer_load_dwordx4 a[16:19], v248, s[40:43], s48 offen sc1
    v_exp_f32 v60, v60
    v_cvt_pk_bf16_f32 v36, v40, v41
    v_exp_f32 v61, v61
    v_cvt_pk_bf16_f32 v37, v42, v43
    v_exp_f32 v62, v62
    v_cvt_pk_bf16_f32 v38, v44, v45
    v_exp_f32 v63, v63
    v_cvt_pk_bf16_f32 v39, v46, v47
    s_waitcnt vmcnt(13)
    ds_write_b64 v9, v[10:11]
    ds_write_b64 v8, v[10:11] offset:8192
    s_waitcnt lgkmcnt(0)
    s_barrier
    ds_read_b64_tr_b16 a[168:169], v15 offset:0
    ds_read_b64_tr_b16 a[170:171], v15 offset:512
    ds_read_b64_tr_b16 a[172:173], v15 offset:2048
    ds_read_b64_tr_b16 a[174:175], v15 offset:2560
    ds_read_b64_tr_b16 a[176:177], v15 offset:4096
    ds_read_b64_tr_b16 a[178:179], v15 offset:4608
    buffer_load_dwordx4 a[20:23], v249, s[40:43], s48 offen sc1
    ds_read_b64_tr_b16 a[180:181], v15 offset:6144
    ds_read_b64_tr_b16 a[182:183], v15 offset:6656
    v_mov_b32 v160, 0x3f803f80
    v_mov_b32 v161, 0x3f803f80
    v_mov_b32 v162, 0x3f803f80
    v_mov_b32 v163, 0x3f803f80
    v_lshlrev_b32 v164, 2, v0
    v_exp_f32 v64, v64
    v_pk_fma_f32 v[80:81], v[80:81], v[146:147], v[148:149] op_sel_hi:[1,0,0]
    v_exp_f32 v65, v65
    v_pk_fma_f32 v[82:83], v[82:83], v[146:147], v[148:149] op_sel_hi:[1,0,0]
    s_add_u32 s48, s48, 14336
    buffer_load_dwordx4 a[24:27], v248, s[40:43], s48 offen sc1
    v_pk_fma_f32 v[84:85], v[84:85], v[146:147], v[148:149] op_sel_hi:[1,0,0]
    v_exp_f32 v66, v66
    v_pk_fma_f32 v[86:87], v[86:87], v[146:147], v[148:149] op_sel_hi:[1,0,0]
    v_pk_fma_f32 v[88:89], v[88:89], v[146:147], v[148:149] op_sel_hi:[1,0,0]
    v_exp_f32 v67, v67
    v_pk_fma_f32 v[90:91], v[90:91], v[146:147], v[148:149] op_sel_hi:[1,0,0]
    v_pk_fma_f32 v[92:93], v[92:93], v[146:147], v[148:149] op_sel_hi:[1,0,0]
    v_exp_f32 v68, v68
    v_pk_fma_f32 v[94:95], v[94:95], v[146:147], v[148:149] op_sel_hi:[1,0,0]
    v_exp_f32 v69, v69
    ds_read_b64_tr_b16 a[184:185], v13 offset:0
    buffer_load_dwordx4 a[28:31], v249, s[40:43], s48 offen sc1
    ds_read_b64_tr_b16 a[186:187], v14 offset:0
    v_exp_f32 v70, v70
    ds_read_b64_tr_b16 a[188:189], v13 offset:256
    ds_read_b64_tr_b16 a[190:191], v14 offset:256
    v_exp_f32 v71, v71
    ds_read_b64_tr_b16 a[248:249], v13 offset:32768
    ds_read_b64_tr_b16 a[250:251], v14 offset:32768
    v_exp_f32 v72, v72
    ds_read_b64_tr_b16 a[252:253], v13 offset:33024
    v_exp_f32 v73, v73
    ds_read_b64_tr_b16 a[254:255], v14 offset:33024
    s_sub_u32 s48, s48, 40960
    buffer_load_dwordx4 a[32:35], v248, s[40:43], s48 offen sc1
    s_waitcnt lgkmcnt(14)
    v_mfma_f32_32x32x16_bf16 v[16:31], v[160:163], a[168:171], 0
    buffer_store_dwordx4 a[168:171], v1, s[40:43], s0 offen offset:0 sc1
    ds_read_b64_tr_b16 a[192:193], v13 offset:4096
    v_exp_f32 v74, v74
    ds_read_b64_tr_b16 a[194:195], v14 offset:4096
    ds_read_b64_tr_b16 a[196:197], v13 offset:4352
    s_waitcnt lgkmcnt(15)
    v_mfma_f32_32x32x16_bf16 v[16:31], v[160:163], a[172:175], v[16:31]
    buffer_store_dwordx4 a[172:175], v1, s[40:43], s0 offen offset:1024 sc1
    v_exp_f32 v75, v75
    ds_read_b64_tr_b16 a[198:199], v14 offset:4352
    v_cvt_pk_bf16_f32 v48, v48, v49
    buffer_load_dwordx4 a[36:39], v249, s[40:43], s48 offen sc1
    v_exp_f32 v76, v76
    v_cvt_pk_bf16_f32 v49, v50, v51
    s_waitcnt lgkmcnt(14)
    v_mfma_f32_32x32x16_bf16 v[16:31], v[160:163], a[176:179], v[16:31]
    buffer_store_dwordx4 a[176:179], v1, s[40:43], s0 offen offset:2048 sc1
    v_exp_f32 v77, v77
    v_cvt_pk_bf16_f32 v50, v52, v53
    v_cvt_pk_bf16_f32 v51, v54, v55
    v_exp_f32 v78, v78
    s_waitcnt lgkmcnt(12)
    v_mfma_f32_32x32x16_bf16 v[16:31], v[160:163], a[180:183], v[16:31]
    buffer_store_dwordx4 a[180:183], v1, s[40:43], s0 offen offset:3072 sc1
    v_cvt_pk_bf16_f32 v52, v56, v57
    v_cvt_pk_bf16_f32 v53, v58, v59
    v_exp_f32 v79, v79
    v_cvt_pk_bf16_f32 v54, v60, v61
    v_cvt_pk_bf16_f32 v55, v62, v63
    v_exp_f32 v80, v80
    v_pk_fma_f32 v[96:97], v[96:97], v[146:147], v[148:149] op_sel_hi:[1,0,0]
    v_pk_fma_f32 v[98:99], v[98:99], v[146:147], v[148:149] op_sel_hi:[1,0,0]
    v_pk_fma_f32 v[100:101], v[100:101], v[146:147], v[148:149] op_sel_hi:[1,0,0]
    s_add_u32 s48, s48, 14336
    buffer_load_dwordx4 a[40:43], v248, s[40:43], s48 offen sc1
    v_pk_fma_f32 v[102:103], v[102:103], v[146:147], v[148:149] op_sel_hi:[1,0,0]
    v_pk_fma_f32 v[104:105], v[104:105], v[146:147], v[148:149] op_sel_hi:[1,0,0]
    v_pk_fma_f32 v[106:107], v[106:107], v[146:147], v[148:149] op_sel_hi:[1,0,0]
    v_pk_fma_f32 v[108:109], v[108:109], v[146:147], v[148:149] op_sel_hi:[1,0,0]
    v_exp_f32 v81, v81
    v_pk_fma_f32 v[110:111], v[110:111], v[146:147], v[148:149] op_sel_hi:[1,0,0]
    ds_read_b64_tr_b16 a[200:201], v13 offset:8192
    ds_read_b64_tr_b16 a[202:203], v14 offset:8192
    buffer_load_dwordx4 a[44:47], v249, s[40:43], s48 offen sc1
    s_mov_b32 exec_hi, 0
    buffer_store_dword v16, v164, s[40:43], s1 offen sc1
    s_mov_b32 exec_hi, -1
    ds_read_b64_tr_b16 a[204:205], v13 offset:8448
    ds_read_b64_tr_b16 a[206:207], v14 offset:8448
    ds_read_b64_tr_b16 a[208:209], v13 offset:12288
    ds_read_b64_tr_b16 a[210:211], v14 offset:12288
    v_exp_f32 v82, v82
    ds_read_b64_tr_b16 a[212:213], v13 offset:12544
    ds_read_b64_tr_b16 a[214:215], v14 offset:12544
    s_add_u32 s48, s48, 14336
    buffer_load_dwordx4 a[48:51], v248, s[40:43], s48 offen sc1
    ds_read_b64_tr_b16 a[216:217], v13 offset:16384
    ds_read_b64_tr_b16 a[218:219], v14 offset:16384
    ds_read_b64_tr_b16 a[220:221], v13 offset:16640
    ds_read_b64_tr_b16 a[222:223], v14 offset:16640
    v_cvt_pk_bf16_f32 v64, v64, v65
    v_exp_f32 v83, v83
    v_cvt_pk_bf16_f32 v65, v66, v67
    v_cvt_pk_bf16_f32 v66, v68, v69
    v_cvt_pk_bf16_f32 v67, v70, v71
    buffer_load_dwordx4 a[52:55], v249, s[40:43], s48 offen sc1
    v_cvt_pk_bf16_f32 v68, v72, v73
    v_cvt_pk_bf16_f32 v69, v74, v75
    v_cvt_pk_bf16_f32 v70, v76, v77
    v_cvt_pk_bf16_f32 v71, v78, v79
    s_waitcnt lgkmcnt(15)
    v_mfma_f32_32x32x16_bf16 v[208:223], a[184:187], v[192:195], 0
    v_exp_f32 v84, v84
    v_exp_f32 v85, v85
    v_exp_f32 v86, v86
    s_add_u32 s48, s48, 14336
    buffer_load_dwordx4 a[56:59], v248, s[40:43], s48 offen sc1
    v_mfma_f32_32x32x16_bf16 v[208:223], a[188:191], v[196:199], v[208:223]
    v_exp_f32 v87, v87
    v_exp_f32 v88, v88
    v_exp_f32 v89, v89
    v_mfma_f32_32x32x16_bf16 v[208:223], a[248:251], v[200:203], v[208:223]
    v_exp_f32 v90, v90
    v_exp_f32 v91, v91
    v_exp_f32 v92, v92
    v_mfma_f32_32x32x16_bf16 v[208:223], a[252:255], v[204:207], v[208:223]
    v_exp_f32 v93, v93
    v_exp_f32 v94, v94
    v_exp_f32 v95, v95
    v_exp_f32 v96, v96
    v_pk_fma_f32 v[112:113], v[112:113], v[146:147], v[148:149] op_sel_hi:[1,0,0]
    v_pk_fma_f32 v[114:115], v[114:115], v[146:147], v[148:149] op_sel_hi:[1,0,0]
    v_pk_fma_f32 v[116:117], v[116:117], v[146:147], v[148:149] op_sel_hi:[1,0,0]
    buffer_load_dwordx4 a[60:63], v249, s[40:43], s48 offen sc1
    v_pk_fma_f32 v[118:119], v[118:119], v[146:147], v[148:149] op_sel_hi:[1,0,0]
    v_pk_fma_f32 v[120:121], v[120:121], v[146:147], v[148:149] op_sel_hi:[1,0,0]
    v_pk_fma_f32 v[122:123], v[122:123], v[146:147], v[148:149] op_sel_hi:[1,0,0]
    v_pk_fma_f32 v[124:125], v[124:125], v[146:147], v[148:149] op_sel_hi:[1,0,0]
    v_exp_f32 v97, v97
    v_pk_fma_f32 v[126:127], v[126:127], v[146:147], v[148:149] op_sel_hi:[1,0,0]
    ds_read_b64_tr_b16 a[224:225], v13 offset:20480
    ds_read_b64_tr_b16 a[226:227], v14 offset:20480
    s_sub_u32 s48, s48, 40960
    buffer_load_dwordx4 a[64:67], v248, s[40:43], s48 offen sc1
    ds_read_b64_tr_b16 a[228:229], v13 offset:20736
    ds_read_b64_tr_b16 a[230:231], v14 offset:20736
    ds_read_b64_tr_b16 a[232:233], v13 offset:24576
    ds_read_b64_tr_b16 a[234:235], v14 offset:24576
    v_exp_f32 v98, v98
    ds_read_b64_tr_b16 a[236:237], v13 offset:24832
    ds_read_b64_tr_b16 a[238:239], v14 offset:24832
    ds_read_b64_tr_b16 a[240:241], v13 offset:28672
    buffer_load_dwordx4 a[68:71], v249, s[40:43], s48 offen sc1
    ds_read_b64_tr_b16 a[242:243], v14 offset:28672
    ds_read_b64_tr_b16 a[244:245], v13 offset:28928
    ds_read_b64_tr_b16 a[246:247], v14 offset:28928
    v_cvt_pk_bf16_f32 v80, v80, v81
    v_exp_f32 v99, v99
    v_cvt_pk_bf16_f32 v81, v82, v83
    v_cvt_pk_bf16_f32 v82, v84, v85
    v_cvt_pk_bf16_f32 v83, v86, v87
    s_add_u32 s48, s48, 14336
    buffer_load_dwordx4 a[72:75], v248, s[40:43], s48 offen sc1
    v_cvt_pk_bf16_f32 v84, v88, v89
    v_cvt_pk_bf16_f32 v85, v90, v91
    v_cvt_pk_bf16_f32 v86, v92, v93
    v_cvt_pk_bf16_f32 v87, v94, v95
    s_waitcnt lgkmcnt(15)
    v_mfma_f32_32x32x16_bf16 v[208:223], a[192:195], v[32:35], v[208:223]
    v_exp_f32 v100, v100
    v_exp_f32 v101, v101
    v_exp_f32 v102, v102
    buffer_load_dwordx4 a[76:79], v249, s[40:43], s48 offen sc1
    v_mfma_f32_32x32x16_bf16 v[208:223], a[196:199], v[36:39], v[208:223]
    v_exp_f32 v103, v103
    v_exp_f32 v104, v104
    v_exp_f32 v105, v105
    v_mfma_f32_32x32x16_bf16 v[208:223], a[200:203], v[48:51], v[208:223]
    v_exp_f32 v106, v106
    v_exp_f32 v107, v107
    v_exp_f32 v108, v108
    v_mfma_f32_32x32x16_bf16 v[208:223], a[204:207], v[52:55], v[208:223]
    v_exp_f32 v109, v109
    v_exp_f32 v110, v110
    v_exp_f32 v111, v111
    v_exp_f32 v112, v112
    v_pk_fma_f32 v[128:129], v[128:129], v[146:147], v[148:149] op_sel_hi:[1,0,0]
    v_pk_fma_f32 v[130:131], v[130:131], v[146:147], v[148:149] op_sel_hi:[1,0,0]
    s_add_u32 s48, s48, 14336
    buffer_load_dwordx4 a[80:83], v248, s[40:43], s48 offen sc1
    v_pk_fma_f32 v[132:133], v[132:133], v[146:147], v[148:149] op_sel_hi:[1,0,0]
    v_pk_fma_f32 v[134:135], v[134:135], v[146:147], v[148:149] op_sel_hi:[1,0,0]
    v_exp_f32 v113, v113
    v_pk_fma_f32 v[136:137], v[136:137], v[146:147], v[148:149] op_sel_hi:[1,0,0]
    v_pk_fma_f32 v[138:139], v[138:139], v[146:147], v[148:149] op_sel_hi:[1,0,0]
    v_pk_fma_f32 v[140:141], v[140:141], v[146:147], v[148:149] op_sel_hi:[1,0,0]
    buffer_load_dwordx4 a[84:87], v249, s[40:43], s48 offen sc1
    v_pk_fma_f32 v[142:143], v[142:143], v[146:147], v[148:149] op_sel_hi:[1,0,0]
    v_exp_f32 v114, v114
    v_cvt_pk_bf16_f32 v96, v96, v97
    v_cvt_pk_bf16_f32 v97, v98, v99
    v_cvt_pk_bf16_f32 v98, v100, v101
    v_cvt_pk_bf16_f32 v99, v102, v103
    s_add_u32 s48, s48, 14336
    buffer_load_dwordx4 a[88:91], v248, s[40:43], s48 offen sc1
    v_exp_f32 v115, v115
    v_cvt_pk_bf16_f32 v100, v104, v105
    v_cvt_pk_bf16_f32 v101, v106, v107
    v_cvt_pk_bf16_f32 v102, v108, v109
    v_cvt_pk_bf16_f32 v103, v110, v111
    v_mfma_f32_32x32x16_bf16 v[208:223], a[208:211], v[64:67], v[208:223]
    buffer_load_dwordx4 a[92:95], v249, s[40:43], s48 offen sc1
    v_exp_f32 v116, v116
    v_exp_f32 v117, v117
    v_exp_f32 v118, v118
    v_mfma_f32_32x32x16_bf16 v[208:223], a[212:215], v[68:71], v[208:223]
    v_exp_f32 v119, v119
    v_exp_f32 v120, v120
    s_sub_u32 s48, s48, 40960
    buffer_load_dwordx4 a[96:99], v248, s[40:43], s48 offen sc1
    v_exp_f32 v121, v121
    s_waitcnt lgkmcnt(14)
    v_mfma_f32_32x32x16_bf16 v[208:223], a[216:219], v[80:83], v[208:223]
    v_exp_f32 v122, v122
    v_exp_f32 v123, v123
    v_exp_f32 v124, v124
    s_waitcnt lgkmcnt(12)
    v_mfma_f32_32x32x16_bf16 v[208:223], a[220:223], v[84:87], v[208:223]
    v_exp_f32 v125, v125
    v_exp_f32 v126, v126
    v_exp_f32 v127, v127
    v_exp_f32 v128, v128
    v_cvt_pk_bf16_f32 v112, v112, v113
    v_cvt_pk_bf16_f32 v113, v114, v115
    v_exp_f32 v129, v129
    v_cvt_pk_bf16_f32 v114, v116, v117
    v_cvt_pk_bf16_f32 v115, v118, v119
    v_exp_f32 v130, v130
    v_cvt_pk_bf16_f32 v116, v120, v121
    v_cvt_pk_bf16_f32 v117, v122, v123
    v_exp_f32 v131, v131
    v_cvt_pk_bf16_f32 v118, v124, v125
    v_cvt_pk_bf16_f32 v119, v126, v127
    s_waitcnt lgkmcnt(10)
    v_mfma_f32_32x32x16_bf16 v[208:223], a[224:227], v[96:99], v[208:223]
    v_exp_f32 v132, v132
    v_exp_f32 v133, v133
    v_exp_f32 v134, v134
    s_waitcnt lgkmcnt(8)
    v_mfma_f32_32x32x16_bf16 v[208:223], a[228:231], v[100:103], v[208:223]
    v_exp_f32 v135, v135
    v_exp_f32 v136, v136
    v_exp_f32 v137, v137
    s_waitcnt lgkmcnt(6)
    v_mfma_f32_32x32x16_bf16 v[208:223], a[232:235], v[112:115], v[208:223]
    v_exp_f32 v138, v138
    v_exp_f32 v139, v139
    v_exp_f32 v140, v140
    s_waitcnt lgkmcnt(4)
    v_mfma_f32_32x32x16_bf16 v[208:223], a[236:239], v[116:119], v[208:223]
    v_exp_f32 v141, v141
    v_exp_f32 v142, v142
    v_exp_f32 v143, v143
    v_cvt_pk_bf16_f32 v128, v128, v129
    v_cvt_pk_bf16_f32 v129, v130, v131
    v_cvt_pk_bf16_f32 v130, v132, v133
    v_cvt_pk_bf16_f32 v131, v134, v135
    v_cvt_pk_bf16_f32 v132, v136, v137
    v_cvt_pk_bf16_f32 v133, v138, v139
    v_cvt_pk_bf16_f32 v134, v140, v141
    v_cvt_pk_bf16_f32 v135, v142, v143
    s_waitcnt lgkmcnt(2)
    v_mfma_f32_32x32x16_bf16 v[208:223], a[240:243], v[128:131], v[208:223]
    s_waitcnt lgkmcnt(0)
    v_mfma_f32_32x32x16_bf16 v[208:223], a[244:247], v[132:135], v[208:223]
    s_waitcnt vmcnt(30)
    s_barrier
    s_nop 9
    v_cndmask_b32 v2, v220, v208, s[26:27]
    v_mov_b32 v3, v2
    s_nop 1
    v_permlane32_swap_b32 v2, v3
    v_cndmask_b32 v2, v3, v2, s[26:27]
    v_rcp_f32 v2, v2
    s_lshl_b32 s16, s8, 2
    s_add_u32 s16, s16, s3
    s_lshl_b32 s16, s16, 4
    s_add_u32 s16, s16, s9
    s_lshl_b32 s11, s16, 11
    s_add_u32 s11, s11, 5505024
    v_pk_mul_f32 v[208:209], v[208:209], v[2:3] op_sel_hi:[1,0]
    v_pk_mul_f32 v[210:211], v[210:211], v[2:3] op_sel_hi:[1,0]
    v_pk_mul_f32 v[212:213], v[212:213], v[2:3] op_sel_hi:[1,0]
    v_pk_mul_f32 v[214:215], v[214:215], v[2:3] op_sel_hi:[1,0]
    v_pk_mul_f32 v[216:217], v[216:217], v[2:3] op_sel_hi:[1,0]
    v_pk_mul_f32 v[218:219], v[218:219], v[2:3] op_sel_hi:[1,0]
    v_pk_mul_f32 v[220:221], v[220:221], v[2:3] op_sel_hi:[1,0]
    v_pk_mul_f32 v[222:223], v[222:223], v[2:3] op_sel_hi:[1,0]
    v_cvt_pk_bf16_f32 v192, v208, v209
    v_cvt_pk_bf16_f32 v193, v210, v211
    v_cvt_pk_bf16_f32 v194, v212, v213
    v_cvt_pk_bf16_f32 v195, v214, v215
    v_cvt_pk_bf16_f32 v196, v216, v217
    v_cvt_pk_bf16_f32 v197, v218, v219
    v_cvt_pk_bf16_f32 v198, v220, v221
    v_cvt_pk_bf16_f32 v199, v222, v223
    v_and_b32 v192, v192, v6
    v_and_b32 v193, v193, v6
    v_and_b32 v198, v198, v7
    v_and_b32 v199, v199, v7
    buffer_store_dwordx4 v[192:195], v1, s[40:43], s11 offen offset:0 sc1
    buffer_store_dwordx4 v[196:199], v1, s[40:43], s11 offen offset:1024 sc1
    s_lshr_b32 s11, s3, 1
    s_lshl_b32 s11, s11, 15
    s_add_u32 s11, s11, 0
    v_add_u32 v2, s11, v248
    v_add_u32 v3, s11, v249
    ds_read_b128 v[112:115], v2 offset:0
    ds_read_b128 v[116:119], v3 offset:0
    ds_read_b128 v[120:123], v2 offset:2048
    ds_read_b128 v[124:127], v3 offset:2048
    ds_read_b128 v[128:131], v2 offset:4096
    ds_read_b128 v[132:135], v3 offset:4096
    ds_read_b128 v[136:139], v2 offset:6144
    ds_read_b128 v[140:143], v3 offset:6144
    ds_read_b128 v[144:147], v2 offset:8192
    ds_read_b128 v[148:151], v3 offset:8192
    ds_read_b128 v[152:155], v2 offset:10240
    ds_read_b128 v[156:159], v3 offset:10240
    ds_read_b128 v[160:163], v2 offset:12288
    ds_read_b128 v[164:167], v3 offset:12288
    ds_read_b128 v[168:171], v2 offset:14336
    ds_read_b128 v[172:175], v3 offset:14336
    ds_read_b128 v[176:179], v2 offset:16384
    ds_read_b128 v[180:183], v3 offset:16384
    ds_read_b128 v[184:187], v2 offset:18432
    ds_read_b128 v[188:191], v3 offset:18432
    ds_read_b128 v[192:195], v2 offset:20480
    ds_read_b128 v[196:199], v3 offset:20480
    ds_read_b128 v[200:203], v2 offset:22528
    ds_read_b128 v[204:207], v3 offset:22528
    ds_read_b128 v[208:211], v2 offset:24576
    ds_read_b128 v[212:215], v3 offset:24576
    ds_read_b128 v[216:219], v2 offset:26624
    ds_read_b128 v[220:223], v3 offset:26624
    ds_read_b128 v[224:227], v2 offset:28672
    ds_read_b128 v[228:231], v3 offset:28672
    ds_read_b128 v[232:235], v2 offset:30720
    ds_read_b128 v[236:239], v3 offset:30720
    v_lshlrev_b32 v16, 16, v240
    v_and_b32 v17, 0xffff0000, v240
    v_lshlrev_b32 v18, 16, v241
    v_and_b32 v19, 0xffff0000, v241
    v_lshlrev_b32 v20, 16, v242
    v_and_b32 v21, 0xffff0000, v242
    v_lshlrev_b32 v22, 16, v243
    v_and_b32 v23, 0xffff0000, v243
    v_lshlrev_b32 v24, 16, v244
    v_and_b32 v25, 0xffff0000, v244
    v_lshlrev_b32 v26, 16, v245
    v_and_b32 v27, 0xffff0000, v245
    v_lshlrev_b32 v28, 16, v246
    v_and_b32 v29, 0xffff0000, v246
    v_lshlrev_b32 v30, 16, v247
    v_and_b32 v31, 0xffff0000, v247
    s_lshl_b32 s13, s6, 1
    s_and_b32 s12, s3, 1
    s_add_u32 s13, s13, s12
    s_lshr_b32 s12, s3, 1
    s_lshl_b32 s18, s13, 1
    s_add_u32 s18, s18, s12
    s_lshl_b32 s20, s18, 11
    s_add_u32 s20, s20, 24520704
    s_lshl_b32 s18, s18, 14
    s_add_u32 s18, s18, 5505024
    s_xor_b32 s11, s3, 2
    s_lshl_b32 s11, s11, 12
    s_add_u32 s11, s11, 144384
    v_add_u32 v4, s11, v1
    s_lshl_b32 s11, s3, 12
    s_add_u32 s11, s11, 144384
    v_add_u32 v5, s11, v1
    s_lshl_b32 s14, s7, 1
    s_add_u32 s14, s14, s12
    s_mul_i32 s19, s13, 28672
    s_lshl_b32 s12, s14, 11
    s_add_u32 s19, s19, s12
    s_add_u32 s19, s19, 7602176
    s_lshl_b32 s17, s13, 4
    s_add_u32 s17, s17, s14
    s_lshl_b32 s29, s17, 8
    s_add_u32 s29, s29, 9437184
    v_mov_b32 v6, 0x3f803f80
    v_lshlrev_b32 v7, 3, v0
    s_waitcnt vmcnt(0)
    s_lshl_b32 s16, s16, 8
    s_add_u32 s16, s16, 24520704
    s_mov_b64 exec, 0xffff
    buffer_store_dwordx4 v[250:253], v1, s[40:43], s16 offen sc1
    s_mov_b64 exec, -1
    s_waitcnt lgkmcnt(0)
    s_barrier
    s_mul_i32 s11, s6, 7
    s_add_u32 s11, s11, s7
    s_cmp_ge_u32 s7, 7
    s_cselect_b32 s11, 287, s11
    s_lshl_b32 s11, s11, 8
    s_add_u32 s11, s11, 24782848
    s_cmp_eq_u32 s3, 0
    s_cselect_b32 s11, s11, 2146435072
    s_mov_b64 exec, 0xffff
    buffer_store_dwordx4 v[250:253], v1, s[40:43], s11 offen sc1
    s_mov_b64 exec, -1
    buffer_load_dwordx4 a[100:103], v249, s[40:43], s48 offen sc1
    s_add_u32 s48, s48, 14336
    buffer_load_dwordx4 a[104:107], v248, s[40:43], s48 offen sc1
    buffer_load_dwordx4 a[108:111], v249, s[40:43], s48 offen sc1
    s_add_u32 s48, s48, 14336
    buffer_load_dwordx4 a[112:115], v248, s[40:43], s48 offen sc1
    buffer_load_dwordx4 a[116:119], v249, s[40:43], s48 offen sc1
    s_add_u32 s48, s48, 14336
    buffer_load_dwordx4 a[120:123], v248, s[40:43], s48 offen sc1
    buffer_load_dwordx4 a[124:127], v249, s[40:43], s48 offen sc1
    s_sub_u32 s48, s48, 40960
    buffer_load_dwordx4 a[128:131], v248, s[40:43], s48 offen sc1
    buffer_load_dwordx4 a[132:135], v249, s[40:43], s48 offen sc1
    s_add_u32 s48, s48, 14336
    buffer_load_dwordx4 a[136:139], v248, s[40:43], s48 offen sc1
    buffer_load_dwordx4 a[140:143], v249, s[40:43], s48 offen sc1
    s_add_u32 s48, s48, 14336
    buffer_load_dwordx4 a[144:147], v248, s[40:43], s48 offen sc1
    buffer_load_dwordx4 a[148:151], v249, s[40:43], s48 offen sc1
    s_add_u32 s48, s48, 14336
    buffer_load_dwordx4 a[152:155], v248, s[40:43], s48 offen sc1
    s_cmp_ge_u32 s7, 7
    s_cbranch_scc1 L_idle3
    s_load_dword s52, s[34:35], s20 offset:0
    s_load_dword s53, s[34:35], s20 offset:256
    s_load_dword s54, s[34:35], s20 offset:512
    s_load_dword s55, s[34:35], s20 offset:768
    s_load_dword s56, s[34:35], s20 offset:1024
    s_load_dword s57, s[34:35], s20 offset:1280
    s_load_dword s58, s[34:35], s20 offset:1536
    s_load_dword s59, s[34:35], s20 offset:1792
    s_mov_b64 s[14:15], s[34:35]
    s_mov_b32 s13, 3
L_poll_31:
    s_waitcnt lgkmcnt(0)
    s_xor_b64 s[52:53], s[52:53], s[50:51]
    s_xor_b64 s[54:55], s[54:55], s[50:51]
    s_or_b64 s[52:53], s[52:53], s[54:55]
    s_xor_b64 s[56:57], s[56:57], s[50:51]
    s_or_b64 s[52:53], s[52:53], s[56:57]
    s_xor_b64 s[58:59], s[58:59], s[50:51]
    s_or_b64 s[52:53], s[52:53], s[58:59]
    s_cbranch_scc0 L_pdone_32
    s_sub_u32 s13, s13, 1
    s_cbranch_scc1 L_pslow_33
    s_sleep 4
    s_add_u32 s14, s14, 64
    s_addc_u32 s15, s15, 0
    s_load_dword s52, s[14:15], s20 offset:0
    s_load_dword s53, s[14:15], s20 offset:256
    s_load_dword s54, s[14:15], s20 offset:512
    s_load_dword s55, s[14:15], s20 offset:768
    s_load_dword s56, s[14:15], s20 offset:1024
    s_load_dword s57, s[14:15], s20 offset:1280
    s_load_dword s58, s[14:15], s20 offset:1536
    s_load_dword s59, s[14:15], s20 offset:1792
    s_branch L_poll_31
L_pdone_32:
    buffer_load_dwordx4 v[48:51], v1, s[40:43], s18 offen offset:0 sc1
    buffer_load_dwordx4 v[52:55], v1, s[40:43], s18 offen offset:1024 sc1
    buffer_load_dwordx4 v[56:59], v1, s[40:43], s18 offen offset:2048 sc1
    buffer_load_dwordx4 v[60:63], v1, s[40:43], s18 offen offset:3072 sc1
    s_add_u32 s18, s18, 4096
    buffer_load_dwordx4 v[64:67], v1, s[40:43], s18 offen offset:0 sc1
    buffer_load_dwordx4 v[68:71], v1, s[40:43], s18 offen offset:1024 sc1
    buffer_load_dwordx4 v[72:75], v1, s[40:43], s18 offen offset:2048 sc1
    buffer_load_dwordx4 v[76:79], v1, s[40:43], s18 offen offset:3072 sc1
    s_add_u32 s18, s18, 4096
    buffer_load_dwordx4 v[80:83], v1, s[40:43], s18 offen offset:0 sc1
    buffer_load_dwordx4 v[84:87], v1, s[40:43], s18 offen offset:1024 sc1
    buffer_load_dwordx4 v[88:91], v1, s[40:43], s18 offen offset:2048 sc1
    buffer_load_dwordx4 v[92:95], v1, s[40:43], s18 offen offset:3072 sc1
    s_add_u32 s18, s18, 4096
    buffer_load_dwordx4 v[96:99], v1, s[40:43], s18 offen offset:0 sc1
    buffer_load_dwordx4 v[100:103], v1, s[40:43], s18 offen offset:1024 sc1
    buffer_load_dwordx4 v[104:107], v1, s[40:43], s18 offen offset:2048 sc1
    buffer_load_dwordx4 v[108:111], v1, s[40:43], s18 offen offset:3072 sc1
    s_load_dword s52, s[34:35], s23 offset:0
    s_load_dword s53, s[34:35], s23 offset:256
    s_load_dword s54, s[34:35], s23 offset:512
    s_load_dword s55, s[34:35], s23 offset:1792
    s_load_dword s56, s[34:35], s23 offset:2048
    s_load_dword s57, s[34:35], s23 offset:2304
    s_load_dword s58, s[34:35], s23 offset:3584
    s_load_dword s59, s[34:35], s23 offset:3840
    s_load_dword s60, s[34:35], s23 offset:4096
    s_load_dword s61, s[34:35], s23 offset:4096
    s_waitcnt vmcnt(15)
    v_mfma_f32_32x32x16_bf16 v[32:47], v[116:119], v[48:51], 0
    v_mfma_f32_32x32x16_bf16 v[16:31], v[112:115], v[48:51], v[16:31]
    s_waitcnt vmcnt(14)
    v_mfma_f32_32x32x16_bf16 v[32:47], v[124:127], v[52:55], v[32:47]
    v_mfma_f32_32x32x16_bf16 v[16:31], v[120:123], v[52:55], v[16:31]
    s_waitcnt vmcnt(13)
    v_mfma_f32_32x32x16_bf16 v[32:47], v[132:135], v[56:59], v[32:47]
    v_mfma_f32_32x32x16_bf16 v[16:31], v[128:131], v[56:59], v[16:31]
    s_waitcnt vmcnt(12)
    v_mfma_f32_32x32x16_bf16 v[32:47], v[140:143], v[60:63], v[32:47]
    v_mfma_f32_32x32x16_bf16 v[16:31], v[136:139], v[60:63], v[16:31]
    s_mov_b64 s[14:15], s[34:35]
    s_mov_b32 s13, 3
L_poll_34:
    s_waitcnt lgkmcnt(0)
    s_xor_b64 s[52:53], s[52:53], s[50:51]
    s_xor_b64 s[54:55], s[54:55], s[50:51]
    s_or_b64 s[52:53], s[52:53], s[54:55]
    s_xor_b64 s[56:57], s[56:57], s[50:51]
    s_or_b64 s[52:53], s[52:53], s[56:57]
    s_xor_b64 s[58:59], s[58:59], s[50:51]
    s_or_b64 s[52:53], s[52:53], s[58:59]
    s_xor_b64 s[60:61], s[60:61], s[50:51]
    s_or_b64 s[52:53], s[52:53], s[60:61]
    s_cbranch_scc0 L_pdone_35
    s_sub_u32 s13, s13, 1
    s_cbranch_scc1 L_pslow_36
    s_sleep 4
    s_add_u32 s14, s14, 64
    s_addc_u32 s15, s15, 0
    s_load_dword s52, s[14:15], s23 offset:0
    s_load_dword s53, s[14:15], s23 offset:256
    s_load_dword s54, s[14:15], s23 offset:512
    s_load_dword s55, s[14:15], s23 offset:1792
    s_load_dword s56, s[14:15], s23 offset:2048
    s_load_dword s57, s[14:15], s23 offset:2304
    s_load_dword s58, s[14:15], s23 offset:3584
    s_load_dword s59, s[14:15], s23 offset:3840
    s_load_dword s60, s[14:15], s23 offset:4096
    s_load_dword s61, s[14:15], s23 offset:4096
    s_branch L_poll_34
L_pdone_35:
    s_add_u32 m0, s31, 0
    s_add_u32 s49, s30, 0
    buffer_load_dwordx4 v1, s[40:43], s49 offen offset:0 sc1 lds
    s_waitcnt vmcnt(12)
    v_mfma_f32_32x32x16_bf16 v[32:47], v[148:151], v[64:67], v[32:47]
    v_mfma_f32_32x32x16_bf16 v[16:31], v[144:147], v[64:67], v[16:31]
    buffer_load_dwordx4 v1, s[40:43], s49 offen offset:1024 sc1 lds
    s_waitcnt vmcnt(12)
    v_mfma_f32_32x32x16_bf16 v[32:47], v[156:159], v[68:71], v[32:47]
    v_mfma_f32_32x32x16_bf16 v[16:31], v[152:155], v[68:71], v[16:31]
    buffer_load_dwordx4 v1, s[40:43], s49 offen offset:2048 sc1 lds
    s_waitcnt vmcnt(12)
    v_mfma_f32_32x32x16_bf16 v[32:47], v[164:167], v[72:75], v[32:47]
    v_mfma_f32_32x32x16_bf16 v[16:31], v[160:163], v[72:75], v[16:31]
    buffer_load_dwordx4 v1, s[40:43], s49 offen offset:3072 sc1 lds
    s_waitcnt vmcnt(12)
    v_mfma_f32_32x32x16_bf16 v[32:47], v[172:175], v[76:79], v[32:47]
    v_mfma_f32_32x32x16_bf16 v[16:31], v[168:171], v[76:79], v[16:31]
    s_add_u32 m0, s31, 4096
    s_add_u32 s49, s30, 4096
    buffer_load_dwordx4 v1, s[40:43], s49 offen offset:0 sc1 lds
    s_waitcnt vmcnt(12)
    v_mfma_f32_32x32x16_bf16 v[32:47], v[180:183], v[80:83], v[32:47]
    v_mfma_f32_32x32x16_bf16 v[16:31], v[176:179], v[80:83], v[16:31]
    buffer_load_dwordx4 v1, s[40:43], s49 offen offset:1024 sc1 lds
    s_waitcnt vmcnt(12)
    v_mfma_f32_32x32x16_bf16 v[32:47], v[188:191], v[84:87], v[32:47]
    v_mfma_f32_32x32x16_bf16 v[16:31], v[184:187], v[84:87], v[16:31]
    buffer_load_dwordx4 v1, s[40:43], s49 offen offset:2048 sc1 lds
    s_waitcnt vmcnt(12)
    v_mfma_f32_32x32x16_bf16 v[32:47], v[196:199], v[88:91], v[32:47]
    v_mfma_f32_32x32x16_bf16 v[16:31], v[192:195], v[88:91], v[16:31]
    s_add_u32 m0, s31, 28672
    s_add_u32 s49, s30, 28672
    buffer_load_dwordx4 v1, s[40:43], s49 offen offset:0 sc1 lds
    s_waitcnt vmcnt(12)
    v_mfma_f32_32x32x16_bf16 v[32:47], v[204:207], v[92:95], v[32:47]
    v_mfma_f32_32x32x16_bf16 v[16:31], v[200:203], v[92:95], v[16:31]
    s_waitcnt vmcnt(11)
    v_mfma_f32_32x32x16_bf16 v[32:47], v[212:215], v[96:99], v[32:47]
    v_mfma_f32_32x32x16_bf16 v[16:31], v[208:211], v[96:99], v[16:31]
    s_waitcnt vmcnt(10)
    v_mfma_f32_32x32x16_bf16 v[32:47], v[220:223], v[100:103], v[32:47]
    v_mfma_f32_32x32x16_bf16 v[16:31], v[216:219], v[100:103], v[16:31]
    s_waitcnt vmcnt(9)
    v_mfma_f32_32x32x16_bf16 v[32:47], v[228:231], v[104:107], v[32:47]
    v_mfma_f32_32x32x16_bf16 v[16:31], v[224:227], v[104:107], v[16:31]
    s_waitcnt vmcnt(8)
    v_mfma_f32_32x32x16_bf16 v[32:47], v[236:239], v[108:111], v[32:47]
    v_mfma_f32_32x32x16_bf16 v[16:31], v[232:235], v[108:111], v[16:31]
    s_nop 10
    ds_write_b128 v4, v[32:35] offset:0
    ds_write_b128 v4, v[36:39] offset:1024
    ds_write_b128 v4, v[40:43] offset:2048
    ds_write_b128 v4, v[44:47] offset:3072
    s_waitcnt lgkmcnt(0)
    s_barrier
    ds_read_b128 v[48:51], v5 offset:0
    ds_read_b128 v[52:55], v5 offset:1024
    ds_read_b128 v[56:59], v5 offset:2048
    ds_read_b128 v[60:63], v5 offset:3072
    s_waitcnt lgkmcnt(3)
    v_pk_add_f32 v[16:17], v[16:17], v[48:49]
    v_cvt_pk_bf16_f32 v240, v16, v17
    v_pk_add_f32 v[18:19], v[18:19], v[50:51]
    v_cvt_pk_bf16_f32 v241, v18, v19
    s_waitcnt lgkmcnt(2)
    v_pk_add_f32 v[20:21], v[20:21], v[52:53]
    v_cvt_pk_bf16_f32 v242, v20, v21
    v_pk_add_f32 v[22:23], v[22:23], v[54:55]
    v_cvt_pk_bf16_f32 v243, v22, v23
    buffer_store_dwordx4 v[240:243], v1, s[40:43], s19 offen offset:0 sc1
    s_waitcnt lgkmcnt(1)
    v_pk_add_f32 v[24:25], v[24:25], v[56:57]
    v_cvt_pk_bf16_f32 v244, v24, v25
    v_pk_add_f32 v[26:27], v[26:27], v[58:59]
    v_cvt_pk_bf16_f32 v245, v26, v27
    s_waitcnt lgkmcnt(0)
    v_pk_add_f32 v[28:29], v[28:29], v[60:61]
    v_cvt_pk_bf16_f32 v246, v28, v29
    v_pk_add_f32 v[30:31], v[30:31], v[62:63]
    v_cvt_pk_bf16_f32 v247, v30, v31
    buffer_store_dwordx4 v[244:247], v1, s[40:43], s19 offen offset:1024 sc1
    v_dot2_f32_bf16 v8, v240, v6, 0
    v_dot2_f32_bf16 v9, v240, v240, 0
    v_dot2_f32_bf16 v8, v241, v6, v8
    v_dot2_f32_bf16 v9, v241, v241, v9
    v_dot2_f32_bf16 v8, v242, v6, v8
    v_dot2_f32_bf16 v9, v242, v242, v9
    v_dot2_f32_bf16 v8, v243, v6, v8
    v_dot2_f32_bf16 v9, v243, v243, v9
    v_dot2_f32_bf16 v8, v244, v6, v8
    v_dot2_f32_bf16 v9, v244, v244, v9
    v_dot2_f32_bf16 v8, v245, v6, v8
    v_dot2_f32_bf16 v9, v245, v245, v9
    v_dot2_f32_bf16 v8, v246, v6, v8
    v_dot2_f32_bf16 v9, v246, v246, v9
    v_dot2_f32_bf16 v8, v247, v6, v8
    v_dot2_f32_bf16 v9, v247, v247, v9
    s_nop 1
    v_mov_b32 v10, v8
    v_mov_b32 v11, v9
    s_nop 0
    v_permlane32_swap_b32 v8, v10
    v_permlane32_swap_b32 v9, v11
    v_add_f32 v8, v8, v10
    v_add_f32 v9, v9, v11
    s_mov_b32 exec_hi, 0
    buffer_store_dwordx2 v[8:9], v7, s[40:43], s29 offen sc1
    s_mov_b64 exec, -1
L_skip3:
    s_nop 0
    buffer_load_dwordx4 v1, s[40:43], s49 offen offset:1024 sc1 lds
    buffer_load_dwordx4 v1, s[40:43], s49 offen offset:2048 sc1 lds
    buffer_load_dwordx4 v1, s[40:43], s49 offen offset:3072 sc1 lds
    s_add_u32 m0, s31, 32768
    s_add_u32 s49, s30, 32768
    buffer_load_dwordx4 v1, s[40:43], s49 offen offset:0 sc1 lds
    buffer_load_dwordx4 v1, s[40:43], s49 offen offset:1024 sc1 lds
    buffer_load_dwordx4 v1, s[40:43], s49 offen offset:2048 sc1 lds
    s_add_u32 m0, s31, 57344
    s_add_u32 s49, s30, 57344
    buffer_load_dwordx4 v1, s[40:43], s49 offen offset:0 sc1 lds
    buffer_load_dwordx4 v1, s[40:43], s49 offen offset:1024 sc1 lds
    s_cmp_ge_u32 s7, 7
    s_cbranch_scc1 L_skip3b
    s_waitcnt vmcnt(8)
    s_lshl_b32 s17, s17, 10
    s_add_u32 s17, s17, 22424320
    s_mov_b64 exec, 0xffff
    buffer_store_dwordx4 v[250:253], v1, s[40:43], s17 offen sc1
    s_mov_b64 exec, -1
L_skip3b:
    s_barrier
    s_lshl_b32 s11, s3, 1
    v_lshrrev_b32 v112, 5, v0
    v_add_u32 v112, s11, v112
    v_min_u32 v113, 6, v112
    v_mul_u32_u24 v113, 896, v113
    v_and_b32 v114, 31, v0
    v_lshl_add_u32 v113, v114, 2, v113
    s_mul_i32 s11, s5, 6272
    s_add_u32 s11, s11, 20250624
    buffer_load_dword v116, v113, s[40:43], s11 offen offset:0 sc1
    buffer_load_dword v117, v113, s[40:43], s11 offen offset:128 sc1
    buffer_load_dword v118, v113, s[40:43], s11 offen offset:256 sc1
    buffer_load_dword v119, v113, s[40:43], s11 offen offset:384 sc1
    buffer_load_dword v120, v113, s[40:43], s11 offen offset:512 sc1
    buffer_load_dword v121, v113, s[40:43], s11 offen offset:640 sc1
    buffer_load_dword v122, v113, s[40:43], s11 offen offset:768 sc1
    v_lshlrev_b32 v112, 9, v112
    v_lshl_add_u32 v112, v114, 4, v112
    v_add_u32 v112, 143360, v112
    buffer_load_dwordx4 v1, s[40:43], s49 offen offset:2048 sc1 lds
    buffer_load_dwordx4 v1, s[40:43], s49 offen offset:3072 sc1 lds
    s_add_u32 m0, s31, 61440
    s_add_u32 s49, s30, 61440
    buffer_load_dwordx4 v1, s[40:43], s49 offen offset:0 sc1 lds
    buffer_load_dwordx4 v1, s[40:43], s49 offen offset:1024 sc1 lds
    buffer_load_dwordx4 v1, s[40:43], s49 offen offset:2048 sc1 lds
    s_add_u32 m0, s31, 86016
    s_add_u32 s49, s30, 86016
    buffer_load_dwordx4 v1, s[40:43], s49 offen offset:0 sc1 lds
    buffer_load_dwordx4 v1, s[40:43], s49 offen offset:1024 sc1 lds
    buffer_load_dwordx4 v1, s[40:43], s49 offen offset:2048 sc1 lds
    buffer_load_dwordx4 v1, s[40:43], s49 offen offset:3072 sc1 lds
    s_add_u32 m0, s31, 90112
    s_add_u32 s49, s30, 90112
    buffer_load_dwordx4 v1, s[40:43], s49 offen offset:0 sc1 lds
    buffer_load_dwordx4 v1, s[40:43], s49 offen offset:1024 sc1 lds
    buffer_load_dwordx4 v1, s[40:43], s49 offen offset:2048 sc1 lds
    s_waitcnt vmcnt(17)
    v_add_f32 v116, v116, v117
    s_waitcnt vmcnt(16)
    v_add_f32 v116, v116, v118
    s_waitcnt vmcnt(15)
    v_add_f32 v116, v116, v119
    s_waitcnt vmcnt(14)
    v_add_f32 v116, v116, v120
    s_waitcnt vmcnt(13)
    v_add_f32 v116, v116, v121
    s_waitcnt vmcnt(12)
    v_add_f32 v116, v116, v122
    v_mov_b32 v122, 0
    v_mov_b32 v123, 0
    v_cvt_pk_bf16_f32 v121, v116, 0
    v_lshlrev_b32 v117, 16, v121
    v_sub_f32 v117, v116, v117
    v_cvt_pk_bf16_f32 v120, v116, v117
    ds_write_b128 v112, v[120:123]
    s_lshl_b32 s13, s4, 2
    s_add_u32 s13, s13, s3
    s_mul_i32 s18, s13, 28672
    s_add_u32 s18, s18, 7602176
    s_lshl_b32 s20, s13, 14
    s_add_u32 s20, s20, 22424320
    v_and_b32 v2, 31, v0
    v_lshlrev_b32 v2, 3, v2
    v_lshrrev_b32 v3, 5, v0
    v_mul_u32_u24 v4, 1792, v3
    v_add_u32 v14, v2, v4
    s_lshl_b32 s19, s13, 12
    s_add_u32 s19, s19, 9437184
    v_add_u32 v5, 57344, v1
    v_add_u32 v6, 114688, v1
    v_and_b32 v7, 0x1f0, v1
    v_add_u32 v7, 143360, v7
    s_mul_i32 s29, s13, 114688
    s_mul_i32 s12, s5, 7168
    s_add_u32 s29, s29, s12
    s_add_u32 s29, s29, 9699328
    s_add_u32 s28, s29, 4096
    s_lshl_b32 s27, s13, 4
    s_add_u32 s27, s27, s5
    s_cmp_ge_u32 s7, 7
    s_cbranch_scc1 L_idle3b
L_go4:
    s_load_dword s52, s[34:35], s20 offset:0
    s_load_dword s53, s[34:35], s20 offset:1024
    s_load_dword s54, s[34:35], s20 offset:2048
    s_load_dword s55, s[34:35], s20 offset:3072
    s_load_dword s56, s[34:35], s20 offset:4096
    s_load_dword s57, s[34:35], s20 offset:5120
    s_load_dword s58, s[34:35], s20 offset:6144
    s_load_dword s59, s[34:35], s20 offset:7168
    s_load_dword s60, s[34:35], s20 offset:8192
    s_load_dword s61, s[34:35], s20 offset:9216
    s_load_dword s62, s[34:35], s20 offset:10240
    s_load_dword s63, s[34:35], s20 offset:11264
    s_load_dword s64, s[34:35], s20 offset:12288
    s_load_dword s65, s[34:35], s20 offset:13312
    s_mov_b64 s[14:15], s[34:35]
    s_mov_b32 s13, 3
L_poll_37:
    s_waitcnt lgkmcnt(0)
    s_xor_b64 s[52:53], s[52:53], s[50:51]
    s_xor_b64 s[54:55], s[54:55], s[50:51]
    s_or_b64 s[52:53], s[52:53], s[54:55]
    s_xor_b64 s[56:57], s[56:57], s[50:51]
    s_or_b64 s[52:53], s[52:53], s[56:57]
    s_xor_b64 s[58:59], s[58:59], s[50:51]
    s_or_b64 s[52:53], s[52:53], s[58:59]
    s_xor_b64 s[60:61], s[60:61], s[50:51]
    s_or_b64 s[52:53], s[52:53], s[60:61]
    s_xor_b64 s[62:63], s[62:63], s[50:51]
    s_or_b64 s[52:53], s[52:53], s[62:63]
    s_xor_b64 s[64:65], s[64:65], s[50:51]
    s_or_b64 s[52:53], s[52:53], s[64:65]
    s_cbranch_scc0 L_pdone_38
    s_sub_u32 s13, s13, 1
    s_cbranch_scc1 L_pslow_39
    s_sleep 4
    s_add_u32 s14, s14, 64
    s_addc_u32 s15, s15, 0
    s_load_dword s52, s[14:15], s20 offset:0
    s_load_dword s53, s[14:15], s20 offset:1024
    s_load_dword s54, s[14:15], s20 offset:2048
    s_load_dword s55, s[14:15], s20 offset:3072
    s_load_dword s56, s[14:15], s20 offset:4096
    s_load_dword s57, s[14:15], s20 offset:5120
    s_load_dword s58, s[14:15], s20 offset:6144
    s_load_dword s59, s[14:15], s20 offset:7168
    s_load_dword s60, s[14:15], s20 offset:8192
    s_load_dword s61, s[14:15], s20 offset:9216
    s_load_dword s62, s[14:15], s20 offset:10240
    s_load_dword s63, s[14:15], s20 offset:11264
    s_load_dword s64, s[14:15], s20 offset:12288
    s_load_dword s65, s[14:15], s20 offset:13312
    s_branch L_poll_37
L_pdone_38:
    buffer_load_dwordx4 v[16:19], v1, s[40:43], s18 offen offset:0 sc1
    buffer_load_dwordx4 v[20:23], v1, s[40:43], s18 offen offset:1024 sc1
    buffer_load_dwordx4 v[24:27], v1, s[40:43], s18 offen offset:2048 sc1
    buffer_load_dwordx4 v[28:31], v1, s[40:43], s18 offen offset:3072 sc1
    s_add_u32 s18, s18, 4096
    buffer_load_dwordx4 v[32:35], v1, s[40:43], s18 offen offset:0 sc1
    buffer_load_dwordx4 v[36:39], v1, s[40:43], s18 offen offset:1024 sc1
    buffer_load_dwordx4 v[40:43], v1, s[40:43], s18 offen offset:2048 sc1
    buffer_load_dwordx4 v[44:47], v1, s[40:43], s18 offen offset:3072 sc1
    s_add_u32 s18, s18, 4096
    buffer_load_dwordx4 v[48:51], v1, s[40:43], s18 offen offset:0 sc1
    buffer_load_dwordx4 v[52:55], v1, s[40:43], s18 offen offset:1024 sc1
    buffer_load_dwordx4 v[56:59], v1, s[40:43], s18 offen offset:2048 sc1
    buffer_load_dwordx4 v[60:63], v1, s[40:43], s18 offen offset:3072 sc1
    s_add_u32 s18, s18, 4096
    s_waitcnt vmcnt(19)
    s_waitcnt lgkmcnt(0)
    s_barrier
    ds_read_b128 a[224:227], v1 offset:0
    ds_read_b128 a[228:231], v1 offset:28672
    ds_read_b128 a[232:235], v5 offset:0
    ds_read_b128 a[236:239], v1 offset:1024
    ds_read_b128 a[240:243], v1 offset:29696
    ds_read_b128 a[244:247], v5 offset:1024
    ds_read_b128 a[248:251], v1 offset:2048
    s_waitcnt vmcnt(11) lgkmcnt(6)
    v_mfma_f32_32x32x16_bf16 v[128:143], a[224:227], v[16:19], 0
    ds_read_b128 a[252:255], v1 offset:30720
    buffer_load_dwordx4 v[64:67], v1, s[40:43], s18 offen offset:0 sc1
    s_waitcnt lgkmcnt(6)
    v_mfma_f32_32x32x16_bf16 v[144:159], a[228:231], v[16:19], 0
    ds_read_b128 a[224:227], v5 offset:2048
    s_waitcnt lgkmcnt(5)
    v_mfma_f32_32x32x16_bf16 v[160:175], a[232:235], v[16:19], 0
    ds_read_b128 a[228:231], v1 offset:3072
    buffer_load_dwordx4 v[68:71], v1, s[40:43], s18 offen offset:1024 sc1
    s_waitcnt vmcnt(12)
    v_mfma_f32_32x32x16_bf16 v[128:143], a[236:239], v[20:23], v[128:143]
    ds_read_b128 a[232:235], v1 offset:31744
    s_waitcnt lgkmcnt(5)
    v_mfma_f32_32x32x16_bf16 v[144:159], a[240:243], v[20:23], v[144:159]
    ds_read_b128 a[236:239], v5 offset:3072
    buffer_load_dwordx4 v[72:75], v1, s[40:43], s18 offen offset:2048 sc1
    v_mfma_f32_32x32x16_bf16 v[160:175], a[244:247], v[20:23], v[160:175]
    ds_read_b128 a[240:243], v1 offset:4096
    s_waitcnt lgkmcnt(5)
    s_waitcnt vmcnt(12)
    v_mfma_f32_32x32x16_bf16 v[128:143], a[248:251], v[24:27], v[128:143]
    ds_read_b128 a[244:247], v1 offset:32768
    buffer_load_dwordx4 v[76:79], v1, s[40:43], s18 offen offset:3072 sc1
    v_mfma_f32_32x32x16_bf16 v[144:159], a[252:255], v[24:27], v[144:159]
    ds_read_b128 a[248:251], v5 offset:4096
    s_waitcnt lgkmcnt(5)
    v_mfma_f32_32x32x16_bf16 v[160:175], a[224:227], v[24:27], v[160:175]
    s_barrier
    ds_read_b128 a[252:255], v5 offset:28672
    s_add_u32 s18, s18, 4096
    buffer_load_dwordx4 v[80:83], v1, s[40:43], s18 offen offset:0 sc1
    s_waitcnt vmcnt(13)
    v_mfma_f32_32x32x16_bf16 v[128:143], a[228:231], v[28:31], v[128:143]
    ds_read_b128 a[224:227], v1 offset:5120
    s_waitcnt lgkmcnt(5)
    v_mfma_f32_32x32x16_bf16 v[144:159], a[232:235], v[28:31], v[144:159]
    ds_read_b128 a[228:231], v1 offset:33792
    buffer_load_dwordx4 v[84:87], v1, s[40:43], s18 offen offset:1024 sc1
    v_mfma_f32_32x32x16_bf16 v[160:175], a[236:239], v[28:31], v[160:175]
    ds_read_b128 a[232:235], v5 offset:5120
    s_waitcnt lgkmcnt(5)
    s_waitcnt vmcnt(13)
    v_mfma_f32_32x32x16_bf16 v[128:143], a[240:243], v[32:35], v[128:143]
    ds_read_b128 a[236:239], v5 offset:29696
    buffer_load_dwordx4 v[88:91], v1, s[40:43], s18 offen offset:2048 sc1
    v_mfma_f32_32x32x16_bf16 v[144:159], a[244:247], v[32:35], v[144:159]
    ds_read_b128 a[240:243], v1 offset:6144
    s_waitcnt lgkmcnt(5)
    v_mfma_f32_32x32x16_bf16 v[160:175], a[248:251], v[32:35], v[160:175]
    ds_read_b128 a[244:247], v1 offset:34816
    buffer_load_dwordx4 v[92:95], v1, s[40:43], s18 offen offset:3072 sc1
    v_mfma_f32_32x32x16_bf16 v[176:191], a[252:255], v[16:19], 0
    ds_read_b128 a[248:251], v5 offset:6144
    s_waitcnt lgkmcnt(5)
    s_waitcnt vmcnt(14)
    v_mfma_f32_32x32x16_bf16 v[128:143], a[224:227], v[36:39], v[128:143]
    ds_read_b128 a[252:255], v5 offset:30720
    s_add_u32 s18, s18, 4096
    buffer_load_dwordx4 v[96:99], v1, s[40:43], s18 offen offset:0 sc1
    v_mfma_f32_32x32x16_bf16 v[144:159], a[228:231], v[36:39], v[144:159]
    ds_read_b128 a[224:227], v1 offset:7168
    s_waitcnt lgkmcnt(5)
    v_mfma_f32_32x32x16_bf16 v[160:175], a[232:235], v[36:39], v[160:175]
    ds_read_b128 a[228:231], v1 offset:35840
    buffer_load_dwordx4 v[100:103], v1, s[40:43], s18 offen offset:1024 sc1
    v_mfma_f32_32x32x16_bf16 v[176:191], a[236:239], v[20:23], v[176:191]
    ds_read_b128 a[232:235], v5 offset:7168
    s_waitcnt lgkmcnt(5)
    s_waitcnt vmcnt(15)
    v_mfma_f32_32x32x16_bf16 v[128:143], a[240:243], v[40:43], v[128:143]
    ds_read_b128 a[236:239], v5 offset:31744
    buffer_load_dwordx4 v[104:107], v1, s[40:43], s18 offen offset:2048 sc1
    v_mfma_f32_32x32x16_bf16 v[144:159], a[244:247], v[40:43], v[144:159]
    ds_read_b128 a[240:243], v1 offset:8192
    s_waitcnt lgkmcnt(5)
    v_mfma_f32_32x32x16_bf16 v[160:175], a[248:251], v[40:43], v[160:175]
    ds_read_b128 a[244:247], v1 offset:36864
    buffer_load_dwordx4 v[108:111], v1, s[40:43], s18 offen offset:3072 sc1
    v_mfma_f32_32x32x16_bf16 v[176:191], a[252:255], v[24:27], v[176:191]
    ds_read_b128 a[248:251], v5 offset:8192
    s_waitcnt lgkmcnt(5)
    s_waitcnt vmcnt(16)
    v_mfma_f32_32x32x16_bf16 v[128:143], a[224:227], v[44:47], v[128:143]
    ds_read_b128 a[252:255], v5 offset:32768
    s_add_u32 s18, s18, 4096
    buffer_load_dwordx4 v[112:115], v1, s[40:43], s18 offen offset:0 sc1
    v_mfma_f32_32x32x16_bf16 v[144:159], a[228:231], v[44:47], v[144:159]
    ds_read_b128 a[224:227], v1 offset:9216
    s_waitcnt lgkmcnt(5)
    v_mfma_f32_32x32x16_bf16 v[160:175], a[232:235], v[44:47], v[160:175]
    ds_read_b128 a[228:231], v1 offset:37888
    buffer_load_dwordx4 v[116:119], v1, s[40:43], s18 offen offset:1024 sc1
    v_mfma_f32_32x32x16_bf16 v[176:191], a[236:239], v[28:31], v[176:191]
    ds_read_b128 a[232:235], v5 offset:9216
    s_waitcnt lgkmcnt(5)
    s_waitcnt vmcnt(17)
    v_mfma_f32_32x32x16_bf16 v[128:143], a[240:243], v[48:51], v[128:143]
    ds_read_b128 a[236:239], v5 offset:33792
    buffer_load_dwordx4 v[120:123], v1, s[40:43], s18 offen offset:2048 sc1
    v_mfma_f32_32x32x16_bf16 v[144:159], a[244:247], v[48:51], v[144:159]
    ds_read_b128 a[240:243], v5 offset:34816
    s_waitcnt lgkmcnt(5)
    v_mfma_f32_32x32x16_bf16 v[160:175], a[248:251], v[48:51], v[160:175]
    ds_read_b128 a[244:247], v1 offset:10240
    buffer_load_dwordx4 v[124:127], v1, s[40:43], s18 offen offset:3072 sc1
    v_mfma_f32_32x32x16_bf16 v[176:191], a[252:255], v[32:35], v[176:191]
    ds_read_b128 a[248:251], v1 offset:38912
    s_waitcnt lgkmcnt(5)
    s_waitcnt vmcnt(18)
    v_mfma_f32_32x32x16_bf16 v[128:143], a[224:227], v[52:55], v[128:143]
    ds_read_b128 a[252:255], v5 offset:10240
    buffer_load_dwordx2 v[208:209], v14, s[40:43], s19 offen offset:0 sc1
    v_mfma_f32_32x32x16_bf16 v[144:159], a[228:231], v[52:55], v[144:159]
    ds_read_b128 a[224:227], v5 offset:35840
    s_waitcnt lgkmcnt(5)
    v_mfma_f32_32x32x16_bf16 v[160:175], a[232:235], v[52:55], v[160:175]
    ds_read_b128 a[228:231], v1 offset:11264
    buffer_load_dwordx2 v[210:211], v14, s[40:43], s19 offen offset:256 sc1
    v_mfma_f32_32x32x16_bf16 v[176:191], a[236:239], v[36:39], v[176:191]
    ds_read_b128 a[232:235], v1 offset:39936
    s_waitcnt lgkmcnt(5)
    v_mfma_f32_32x32x16_bf16 v[176:191], a[240:243], v[40:43], v[176:191]
    ds_read_b128 a[236:239], v5 offset:11264
    buffer_load_dwordx2 v[212:213], v14, s[40:43], s19 offen offset:512 sc1
    s_waitcnt vmcnt(20)
    v_mfma_f32_32x32x16_bf16 v[128:143], a[244:247], v[56:59], v[128:143]
    ds_read_b128 a[240:243], v5 offset:36864
    s_waitcnt lgkmcnt(5)
    v_mfma_f32_32x32x16_bf16 v[144:159], a[248:251], v[56:59], v[144:159]
    ds_read_b128 a[244:247], v1 offset:12288
    buffer_load_dwordx2 v[214:215], v14, s[40:43], s19 offen offset:768 sc1
    v_mfma_f32_32x32x16_bf16 v[160:175], a[252:255], v[56:59], v[160:175]
    ds_read_b128 a[248:251], v1 offset:40960
    s_waitcnt lgkmcnt(5)
    v_mfma_f32_32x32x16_bf16 v[176:191], a[224:227], v[44:47], v[176:191]
    ds_read_b128 a[252:255], v5 offset:12288
    buffer_load_dwordx2 v[216:217], v14, s[40:43], s19 offen offset:1024 sc1
    s_waitcnt vmcnt(21)
    v_mfma_f32_32x32x16_bf16 v[128:143], a[228:231], v[60:63], v[128:143]
    ds_read_b128 a[224:227], v5 offset:37888
    s_waitcnt lgkmcnt(5)
    v_mfma_f32_32x32x16_bf16 v[144:159], a[232:235], v[60:63], v[144:159]
    ds_read_b128 a[228:231], v1 offset:13312
    buffer_load_dwordx2 v[218:219], v14, s[40:43], s19 offen offset:1280 sc1
    v_mfma_f32_32x32x16_bf16 v[160:175], a[236:239], v[60:63], v[160:175]
    ds_read_b128 a[232:235], v1 offset:41984
    s_waitcnt lgkmcnt(5)
    v_mfma_f32_32x32x16_bf16 v[176:191], a[240:243], v[48:51], v[176:191]
    ds_read_b128 a[236:239], v5 offset:13312
    buffer_load_dwordx2 v[220:221], v14, s[40:43], s19 offen offset:1536 sc1
    s_waitcnt vmcnt(22)
    v_mfma_f32_32x32x16_bf16 v[128:143], a[244:247], v[64:67], v[128:143]
    ds_read_b128 a[240:243], v5 offset:38912
    s_waitcnt lgkmcnt(5)
    v_mfma_f32_32x32x16_bf16 v[144:159], a[248:251], v[64:67], v[144:159]
    ds_read_b128 a[244:247], v1 offset:14336
    s_add_u32 m0, s31, 114688
    s_add_u32 s49, s30, 114688
    buffer_load_dwordx4 v1, s[40:43], s49 offen offset:0 sc1 lds
    v_mfma_f32_32x32x16_bf16 v[160:175], a[252:255], v[64:67], v[160:175]
    ds_read_b128 a[248:251], v1 offset:43008
    s_waitcnt lgkmcnt(5)
    v_mfma_f32_32x32x16_bf16 v[176:191], a[224:227], v[52:55], v[176:191]
    ds_read_b128 a[252:255], v5 offset:14336
    buffer_load_dwordx4 v1, s[40:43], s49 offen offset:1024 sc1 lds
    s_waitcnt vmcnt(23)
    v_mfma_f32_32x32x16_bf16 v[128:143], a[228:231], v[68:71], v[128:143]
    ds_read_b128 a[224:227], v5 offset:39936
    s_waitcnt lgkmcnt(5)
    v_mfma_f32_32x32x16_bf16 v[144:159], a[232:235], v[68:71], v[144:159]
    ds_read_b128 a[228:231], v1 offset:15360
    buffer_load_dwordx4 v1, s[40:43], s49 offen offset:2048 sc1 lds
    v_mfma_f32_32x32x16_bf16 v[160:175], a[236:239], v[68:71], v[160:175]
    ds_read_b128 a[232:235], v1 offset:44032
    s_waitcnt lgkmcnt(5)
    v_mfma_f32_32x32x16_bf16 v[176:191], a[240:243], v[56:59], v[176:191]
    ds_read_b128 a[236:239], v5 offset:15360
    buffer_load_dwordx4 v1, s[40:43], s49 offen offset:3072 sc1 lds
    s_waitcnt vmcnt(24)
    v_mfma_f32_32x32x16_bf16 v[128:143], a[244:247], v[72:75], v[128:143]
    ds_read_b128 a[240:243], v5 offset:40960
    s_waitcnt lgkmcnt(5)
    v_mfma_f32_32x32x16_bf16 v[144:159], a[248:251], v[72:75], v[144:159]
    ds_read_b128 a[244:247], v5 offset:41984
    s_add_u32 m0, s31, 118784
    s_add_u32 s49, s30, 118784
    buffer_load_dwordx4 v1, s[40:43], s49 offen offset:0 sc1 lds
    v_mfma_f32_32x32x16_bf16 v[160:175], a[252:255], v[72:75], v[160:175]
    ds_read_b128 a[248:251], v1 offset:16384
    s_waitcnt lgkmcnt(5)
    v_mfma_f32_32x32x16_bf16 v[176:191], a[224:227], v[60:63], v[176:191]
    ds_read_b128 a[252:255], v1 offset:45056
    buffer_load_dwordx4 v1, s[40:43], s49 offen offset:1024 sc1 lds
    s_waitcnt vmcnt(25)
    v_mfma_f32_32x32x16_bf16 v[128:143], a[228:231], v[76:79], v[128:143]
    ds_read_b128 a[224:227], v5 offset:16384
    s_waitcnt lgkmcnt(5)
    v_mfma_f32_32x32x16_bf16 v[144:159], a[232:235], v[76:79], v[144:159]
    ds_read_b128 a[228:231], v5 offset:43008
    buffer_load_dwordx4 v1, s[40:43], s49 offen offset:2048 sc1 lds
    v_mfma_f32_32x32x16_bf16 v[160:175], a[236:239], v[76:79], v[160:175]
    ds_read_b128 a[232:235], v1 offset:17408
    s_waitcnt lgkmcnt(5)
    v_mfma_f32_32x32x16_bf16 v[176:191], a[240:243], v[64:67], v[176:191]
    ds_read_b128 a[236:239], v1 offset:46080
    buffer_load_dwordx4 a[156:159], v249, s[40:43], s48 offen sc1
    v_mfma_f32_32x32x16_bf16 v[176:191], a[244:247], v[68:71], v[176:191]
    ds_read_b128 a[240:243], v5 offset:17408
    s_waitcnt lgkmcnt(5)
    s_waitcnt vmcnt(26)
    v_mfma_f32_32x32x16_bf16 v[128:143], a[248:251], v[80:83], v[128:143]
    ds_read_b128 a[244:247], v5 offset:44032
    s_sub_u32 s48, s48, 40960
    buffer_load_dwordx4 a[160:163], v248, s[40:43], s48 offen sc1
    v_mfma_f32_32x32x16_bf16 v[144:159], a[252:255], v[80:83], v[144:159]
    ds_read_b128 a[248:251], v1 offset:18432
    s_waitcnt lgkmcnt(5)
    v_mfma_f32_32x32x16_bf16 v[160:175], a[224:227], v[80:83], v[160:175]
    ds_read_b128 a[252:255], v1 offset:47104
    v_mfma_f32_32x32x16_bf16 v[176:191], a[228:231], v[72:75], v[176:191]
    ds_read_b128 a[224:227], v5 offset:18432
    s_waitcnt lgkmcnt(5)
    s_waitcnt vmcnt(26)
    v_mfma_f32_32x32x16_bf16 v[128:143], a[232:235], v[84:87], v[128:143]
    ds_read_b128 a[228:231], v5 offset:45056
    v_mfma_f32_32x32x16_bf16 v[144:159], a[236:239], v[84:87], v[144:159]
    ds_read_b128 a[232:235], v1 offset:19456
    s_waitcnt lgkmcnt(5)
    v_mfma_f32_32x32x16_bf16 v[160:175], a[240:243], v[84:87], v[160:175]
    ds_read_b128 a[236:239], v1 offset:48128
    v_mfma_f32_32x32x16_bf16 v[176:191], a[244:247], v[76:79], v[176:191]
    ds_read_b128 a[240:243], v5 offset:19456
    s_waitcnt lgkmcnt(5)
    s_waitcnt vmcnt(25)
    v_mfma_f32_32x32x16_bf16 v[128:143], a[248:251], v[88:91], v[128:143]
    ds_read_b128 a[244:247], v5 offset:46080
    v_mfma_f32_32x32x16_bf16 v[144:159], a[252:255], v[88:91], v[144:159]
    ds_read_b128 a[248:251], v1 offset:20480
    s_waitcnt lgkmcnt(5)
    v_mfma_f32_32x32x16_bf16 v[160:175], a[224:227], v[88:91], v[160:175]
    ds_read_b128 a[252:255], v1 offset:49152
    s_waitcnt vmcnt(14)
    v_add_f32 v208, v208, v210
    v_add_f32 v209, v209, v211
    v_mfma_f32_32x32x16_bf16 v[176:191], a[228:231], v[80:83], v[176:191]
    ds_read_b128 a[224:227], v5 offset:20480
    s_waitcnt lgkmcnt(5)
    v_mfma_f32_32x32x16_bf16 v[128:143], a[232:235], v[92:95], v[128:143]
    ds_read_b128 a[228:231], v5 offset:47104
    s_waitcnt vmcnt(13)
    v_add_f32 v208, v208, v212
    v_add_f32 v209, v209, v213
    v_mfma_f32_32x32x16_bf16 v[144:159], a[236:239], v[92:95], v[144:159]
    ds_read_b128 a[232:235], v1 offset:21504
    s_waitcnt lgkmcnt(5)
    v_mfma_f32_32x32x16_bf16 v[160:175], a[240:243], v[92:95], v[160:175]
    ds_read_b128 a[236:239], v1 offset:50176
    s_waitcnt vmcnt(12)
    v_add_f32 v208, v208, v214
    v_add_f32 v209, v209, v215
    v_mfma_f32_32x32x16_bf16 v[176:191], a[244:247], v[84:87], v[176:191]
    ds_read_b128 a[240:243], v5 offset:21504
    s_waitcnt vmcnt(11)
    v_add_f32 v208, v208, v216
    s_waitcnt lgkmcnt(5)
    v_mfma_f32_32x32x16_bf16 v[128:143], a[248:251], v[96:99], v[128:143]
    ds_read_b128 a[244:247], v5 offset:48128
    v_add_f32 v209, v209, v217
    v_mfma_f32_32x32x16_bf16 v[144:159], a[252:255], v[96:99], v[144:159]
    ds_read_b128 a[248:251], v5 offset:49152
    s_waitcnt vmcnt(10)
    v_add_f32 v208, v208, v218
    s_waitcnt lgkmcnt(5)
    v_mfma_f32_32x32x16_bf16 v[160:175], a[224:227], v[96:99], v[160:175]
    ds_read_b128 a[252:255], v1 offset:22528
    v_add_f32 v209, v209, v219
    v_mfma_f32_32x32x16_bf16 v[176:191], a[228:231], v[88:91], v[176:191]
    ds_read_b128 a[224:227], v1 offset:51200
    s_waitcnt vmcnt(9)
    v_add_f32 v208, v208, v220
    s_waitcnt lgkmcnt(5)
    v_mfma_f32_32x32x16_bf16 v[128:143], a[232:235], v[100:103], v[128:143]
    ds_read_b128 a[228:231], v5 offset:22528
    v_add_f32 v209, v209, v221
    v_mov_b32 v12, v208
    v_mfma_f32_32x32x16_bf16 v[144:159], a[236:239], v[100:103], v[144:159]
    ds_read_b128 a[232:235], v5 offset:50176
    s_waitcnt lgkmcnt(5)
    v_mfma_f32_32x32x16_bf16 v[160:175], a[240:243], v[100:103], v[160:175]
    ds_read_b128 a[236:239], v1 offset:23552
    v_mov_b32 v13, v209
    v_permlane32_swap_b32 v208, v12
    v_mfma_f32_32x32x16_bf16 v[176:191], a[244:247], v[92:95], v[176:191]
    ds_read_b128 a[240:243], v1 offset:52224
    s_waitcnt lgkmcnt(5)
    v_mfma_f32_32x32x16_bf16 v[176:191], a[248:251], v[96:99], v[176:191]
    ds_read_b128 a[244:247], v5 offset:23552
    v_permlane32_swap_b32 v209, v13
    v_add_f32 v12, v12, v208
    v_mfma_f32_32x32x16_bf16 v[128:143], a[252:255], v[104:107], v[128:143]
    ds_read_b128 a[248:251], v5 offset:51200
    v_add_f32 v13, v13, v209
    s_waitcnt lgkmcnt(5)
    v_mfma_f32_32x32x16_bf16 v[144:159], a[224:227], v[104:107], v[144:159]
    ds_read_b128 a[252:255], v1 offset:24576
    v_mul_f32 v8, 0xbb124925, v12
    v_mfma_f32_32x32x16_bf16 v[160:175], a[228:231], v[104:107], v[160:175]
    ds_read_b128 a[224:227], v1 offset:53248
    v_mul_f32 v13, 0x3b124925, v13
    s_waitcnt lgkmcnt(5)
    v_mfma_f32_32x32x16_bf16 v[176:191], a[232:235], v[100:103], v[176:191]
    ds_read_b128 a[228:231], v5 offset:24576
    v_fma_f32 v13, -v8, v8, v13
    v_mfma_f32_32x32x16_bf16 v[128:143], a[236:239], v[108:111], v[128:143]
    ds_read_b128 a[232:235], v5 offset:52224
    v_max_f32 v13, 0, v13
    s_waitcnt lgkmcnt(5)
    v_mfma_f32_32x32x16_bf16 v[144:159], a[240:243], v[108:111], v[144:159]
    ds_read_b128 a[236:239], v1 offset:25600
    v_add_f32 v11, 0x3727c5ac, v13
    v_mfma_f32_32x32x16_bf16 v[160:175], a[244:247], v[108:111], v[160:175]
    ds_read_b128 a[240:243], v1 offset:54272
    s_waitcnt lgkmcnt(5)
    v_mfma_f32_32x32x16_bf16 v[176:191], a[248:251], v[104:107], v[176:191]
    ds_read_b128 a[244:247], v5 offset:25600
    v_rsq_f32 v12, v11
    s_nop 0
    v_mul_f32 v9, 0xc0135761, v12
    v_mfma_f32_32x32x16_bf16 v[128:143], a[252:255], v[112:115], v[128:143]
    ds_read_b128 a[248:251], v5 offset:53248
    s_waitcnt lgkmcnt(5)
    v_mfma_f32_32x32x16_bf16 v[144:159], a[224:227], v[112:115], v[144:159]
    ds_read_b128 a[252:255], v1 offset:26624
    v_mul_f32 v13, v12, v12
    v_mul_f32 v10, v9, v13
    v_mfma_f32_32x32x16_bf16 v[160:175], a[228:231], v[112:115], v[160:175]
    ds_read_b128 a[224:227], v1 offset:55296
    s_waitcnt lgkmcnt(5)
    v_mfma_f32_32x32x16_bf16 v[176:191], a[232:235], v[108:111], v[176:191]
    ds_read_b128 a[228:231], v5 offset:26624
    v_mul_f32 v10, 0x3d372713, v10
    s_mov_b32 s12, -1
    v_mfma_f32_32x32x16_bf16 v[128:143], a[236:239], v[116:119], v[128:143]
    ds_read_b128 a[232:235], v5 offset:54272
    s_mov_b32 s13, 0
    s_waitcnt lgkmcnt(5)
    v_mfma_f32_32x32x16_bf16 v[144:159], a[240:243], v[116:119], v[144:159]
    ds_read_b128 a[236:239], v1 offset:27648
    v_cndmask_b32 v8, 0, v8, s[12:13]
    v_mfma_f32_32x32x16_bf16 v[160:175], a[244:247], v[116:119], v[160:175]
    ds_read_b128 a[240:243], v1 offset:56320
    v_mov_b32 v210, 0
    s_waitcnt lgkmcnt(5)
    v_mfma_f32_32x32x16_bf16 v[176:191], a[248:251], v[112:115], v[176:191]
    ds_read_b128 a[244:247], v5 offset:27648
    v_mov_b32 v211, 0
    v_mfma_f32_32x32x16_bf16 v[128:143], a[252:255], v[120:123], v[128:143]
    ds_read_b128 a[248:251], v5 offset:55296
    v_cvt_pk_bf16_f32 v208, v8, v8
    s_waitcnt lgkmcnt(5)
    v_mfma_f32_32x32x16_bf16 v[144:159], a[224:227], v[120:123], v[144:159]
    ds_read_b128 a[252:255], v5 offset:56320
    v_lshlrev_b32 v12, 16, v208
    v_mfma_f32_32x32x16_bf16 v[160:175], a[228:231], v[120:123], v[160:175]
    ds_read_b128 a[224:227], v7 offset:0
    v_sub_f32 v12, v8, v12
    s_waitcnt lgkmcnt(5)
    v_mfma_f32_32x32x16_bf16 v[176:191], a[232:235], v[116:119], v[176:191]
    ds_read_b128 a[228:231], v7 offset:512
    v_cvt_pk_bf16_f32 v209, v12, 0
    v_mfma_f32_32x32x16_bf16 v[128:143], a[236:239], v[124:127], v[128:143]
    ds_read_b128 a[232:235], v7 offset:1024
    s_waitcnt lgkmcnt(5)
    v_mfma_f32_32x32x16_bf16 v[144:159], a[240:243], v[124:127], v[144:159]
    ds_read_b128 a[236:239], v7 offset:1536
    v_mfma_f32_32x32x16_bf16 v[160:175], a[244:247], v[124:127], v[160:175]
    s_waitcnt vmcnt(2)
    s_waitcnt lgkmcnt(0)
    s_barrier
    ds_read_b128 a[240:243], v6 offset:0
    v_mfma_f32_32x32x16_bf16 v[176:191], a[248:251], v[120:123], v[176:191]
    ds_read_b128 a[244:247], v6 offset:1024
    v_mfma_f32_32x32x16_bf16 v[176:191], a[252:255], v[124:127], v[176:191]
    ds_read_b128 a[248:251], v6 offset:2048
    v_mfma_f32_32x32x16_bf16 v[128:143], a[224:227], v[208:211], v[128:143]
    ds_read_b128 a[252:255], v6 offset:3072
    v_mfma_f32_32x32x16_bf16 v[144:159], a[228:231], v[208:211], v[144:159]
    ds_read_b128 a[224:227], v6 offset:4096
    v_mfma_f32_32x32x16_bf16 v[160:175], a[232:235], v[208:211], v[160:175]
    ds_read_b128 a[228:231], v6 offset:5120
    v_mfma_f32_32x32x16_bf16 v[176:191], a[236:239], v[208:211], v[176:191]
    ds_read_b128 a[232:235], v6 offset:6144
    s_waitcnt lgkmcnt(5)
    v_mfma_f32_32x32x16_bf16 v[192:207], a[240:243], v[16:19], 0
    ds_read_b128 a[236:239], v6 offset:7168
    s_add_u32 m0, s31, 0
    s_add_u32 s49, s30, 143360
    buffer_load_dwordx4 v1, s[40:43], s49 offen offset:0 sc1 lds
    s_and_b32 s13, s3, 1
    v_mfma_f32_32x32x16_bf16 v[192:207], a[244:247], v[20:23], v[192:207]
    ds_read_b128 a[240:243], v6 offset:8192
    buffer_load_dwordx4 v1, s[40:43], s49 offen offset:1024 sc1 lds
    s_lshl_b32 s14, s6, 1
    s_waitcnt lgkmcnt(5)
    v_pk_mul_f32 v[224:225], v[128:129], v[128:129]
    v_pk_mul_f32 v[226:227], v[130:131], v[130:131]
    v_pk_mul_f32 v[228:229], v[132:133], v[132:133]
    v_pk_mul_f32 v[230:231], v[134:135], v[134:135]
    v_pk_fma_f32 v[224:225], v[224:225], v[10:11], v[8:9] op_sel:[0,0,1] op_sel_hi:[1,0,1]
    v_pk_fma_f32 v[226:227], v[226:227], v[10:11], v[8:9] op_sel:[0,0,1] op_sel_hi:[1,0,1]
    v_pk_fma_f32 v[228:229], v[228:229], v[10:11], v[8:9] op_sel:[0,0,1] op_sel_hi:[1,0,1]
    v_pk_fma_f32 v[230:231], v[230:231], v[10:11], v[8:9] op_sel:[0,0,1] op_sel_hi:[1,0,1]
    v_pk_mul_f32 v[136:137], v[128:129], v[136:137]
    v_pk_mul_f32 v[138:139], v[130:131], v[138:139]
    v_pk_mul_f32 v[140:141], v[132:133], v[140:141]
    v_pk_mul_f32 v[142:143], v[134:135], v[142:143]
    v_pk_mul_f32 v[128:129], v[224:225], v[128:129]
    v_pk_mul_f32 v[130:131], v[226:227], v[130:131]
    v_pk_mul_f32 v[132:133], v[228:229], v[132:133]
    v_pk_mul_f32 v[134:135], v[230:231], v[134:135]
    v_mfma_f32_32x32x16_bf16 v[192:207], a[248:251], v[24:27], v[192:207]
    ds_read_b128 a[244:247], v6 offset:9216
    buffer_load_dwordx4 v1, s[40:43], s49 offen offset:2048 sc1 lds
    v_exp_f32 v128, v128
    v_exp_f32 v129, v129
    v_exp_f32 v130, v130
    v_fma_f32 v128, v128, v11, v11
    v_exp_f32 v131, v131
    s_lshl_b32 s20, s14, 14
    v_mfma_f32_32x32x16_bf16 v[192:207], a[252:255], v[28:31], v[192:207]
    ds_read_b128 a[248:251], v6 offset:10240
    buffer_load_dwordx4 v1, s[40:43], s49 offen offset:3072 sc1 lds
    v_fma_f32 v129, v129, v11, v11
    v_exp_f32 v132, v132
    s_lshl_b32 s15, s3, 12
    s_waitcnt lgkmcnt(5)
    v_mfma_f32_32x32x16_bf16 v[192:207], a[224:227], v[32:35], v[192:207]
    ds_read_b128 a[252:255], v6 offset:11264
    s_add_u32 m0, s31, 4096
    s_add_u32 s49, s30, 147456
    buffer_load_dwordx4 v1, s[40:43], s49 offen offset:0 sc1 lds
    v_fma_f32 v130, v130, v11, v11
    s_add_u32 s20, s20, s15
    v_mfma_f32_32x32x16_bf16 v[192:207], a[228:231], v[36:39], v[192:207]
    ds_read_b128 a[224:227], v6 offset:12288
    buffer_load_dwordx4 v1, s[40:43], s49 offen offset:1024 sc1 lds
    v_exp_f32 v133, v133
    v_fma_f32 v131, v131, v11, v11
    s_add_u32 s20, s20, 23472128
    s_waitcnt lgkmcnt(5)
    v_mfma_f32_32x32x16_bf16 v[192:207], a[232:235], v[40:43], v[192:207]
    ds_read_b128 a[228:231], v6 offset:13312
    buffer_load_dwordx4 v1, s[40:43], s49 offen offset:2048 sc1 lds
    v_exp_f32 v134, v134
    v_fma_f32 v132, v132, v11, v11
    v_mfma_f32_32x32x16_bf16 v[192:207], a[236:239], v[44:47], v[192:207]
    ds_read_b128 a[232:235], v6 offset:14336
    v_exp_f32 v135, v135
    v_fma_f32 v133, v133, v11, v11
    v_fma_f32 v134, v134, v11, v11
    v_fma_f32 v135, v135, v11, v11
    v_rcp_f32 v128, v128
    s_add_u32 s13, s14, s13
    s_waitcnt lgkmcnt(5)
    v_mfma_f32_32x32x16_bf16 v[192:207], a[240:243], v[48:51], v[192:207]
    ds_read_b128 a[236:239], v6 offset:15360
    s_add_u32 m0, s31, 28672
    s_add_u32 s49, s30, 172032
    buffer_load_dwordx4 v1, s[40:43], s49 offen offset:0 sc1 lds
    v_rcp_f32 v129, v129
    v_mfma_f32_32x32x16_bf16 v[192:207], a[244:247], v[52:55], v[192:207]
    ds_read_b128 a[240:243], v6 offset:16384
    v_rcp_f32 v130, v130
    v_mul_f32 v128, v128, v136
    v_rcp_f32 v131, v131
    v_mul_f32 v129, v129, v137
    s_xor_b32 s12, s13, 1
    s_waitcnt lgkmcnt(5)
    v_mfma_f32_32x32x16_bf16 v[192:207], a[248:251], v[56:59], v[192:207]
    ds_read_b128 a[244:247], v6 offset:17408
    buffer_load_dwordx4 v1, s[40:43], s49 offen offset:1024 sc1 lds
    v_rcp_f32 v132, v132
    v_mul_f32 v130, v130, v138
    v_mfma_f32_32x32x16_bf16 v[192:207], a[252:255], v[60:63], v[192:207]
    ds_read_b128 a[248:251], v6 offset:18432
    v_rcp_f32 v133, v133
    v_mul_f32 v131, v131, v139
    v_rcp_f32 v134, v134
    v_mul_f32 v132, v132, v140
    s_mul_i32 s14, s3, 28672
    s_waitcnt lgkmcnt(5)
    v_mfma_f32_32x32x16_bf16 v[192:207], a[224:227], v[64:67], v[192:207]
    ds_read_b128 a[252:255], v6 offset:19456
    buffer_load_dwordx4 v1, s[40:43], s49 offen offset:2048 sc1 lds
    v_rcp_f32 v135, v135
    v_mul_f32 v133, v133, v141
    v_mul_f32 v134, v134, v142
    v_mfma_f32_32x32x16_bf16 v[192:207], a[228:231], v[68:71], v[192:207]
    ds_read_b128 a[224:227], v6 offset:20480
    v_mul_f32 v135, v135, v143
    v_cvt_pk_bf16_f32 v232, v128, v129
    v_cvt_pk_bf16_f32 v233, v130, v131
    v_cvt_pk_bf16_f32 v234, v132, v133
    v_cvt_pk_bf16_f32 v235, v134, v135
    s_add_u32 s14, s14, 9699328
    s_waitcnt lgkmcnt(5)
    v_pk_mul_f32 v[224:225], v[144:145], v[144:145]
    v_pk_mul_f32 v[226:227], v[146:147], v[146:147]
    v_pk_mul_f32 v[228:229], v[148:149], v[148:149]
    v_pk_mul_f32 v[230:231], v[150:151], v[150:151]
    v_pk_fma_f32 v[224:225], v[224:225], v[10:11], v[8:9] op_sel:[0,0,1] op_sel_hi:[1,0,1]
    v_pk_fma_f32 v[226:227], v[226:227], v[10:11], v[8:9] op_sel:[0,0,1] op_sel_hi:[1,0,1]
    v_pk_fma_f32 v[228:229], v[228:229], v[10:11], v[8:9] op_sel:[0,0,1] op_sel_hi:[1,0,1]
    v_pk_fma_f32 v[230:231], v[230:231], v[10:11], v[8:9] op_sel:[0,0,1] op_sel_hi:[1,0,1]
    v_pk_mul_f32 v[152:153], v[144:145], v[152:153]
    v_pk_mul_f32 v[154:155], v[146:147], v[154:155]
    v_pk_mul_f32 v[156:157], v[148:149], v[156:157]
    v_pk_mul_f32 v[158:159], v[150:151], v[158:159]
    v_pk_mul_f32 v[144:145], v[224:225], v[144:145]
    v_pk_mul_f32 v[146:147], v[226:227], v[146:147]
    v_pk_mul_f32 v[148:149], v[228:229], v[148:149]
    v_pk_mul_f32 v[150:151], v[230:231], v[150:151]
    v_mfma_f32_32x32x16_bf16 v[192:207], a[232:235], v[72:75], v[192:207]
    ds_read_b128 a[228:231], v6 offset:21504
    buffer_load_dwordx4 v1, s[40:43], s49 offen offset:3072 sc1 lds
    buffer_store_dwordx4 v[232:235], v1, s[40:43], s29 offen offset:0 sc1
    v_exp_f32 v144, v144
    v_mfma_f32_32x32x16_bf16 v[192:207], a[236:239], v[76:79], v[192:207]
    ds_read_b128 a[232:235], v6 offset:22528
    v_exp_f32 v145, v145
    v_exp_f32 v146, v146
    v_fma_f32 v144, v144, v11, v11
    v_exp_f32 v147, v147
    s_cmp_ge_u32 s7, 7
    s_cselect_b32 s14, 2146435072, s14
    s_waitcnt lgkmcnt(5)
    v_mfma_f32_32x32x16_bf16 v[192:207], a[240:243], v[80:83], v[192:207]
    ds_read_b128 a[236:239], v6 offset:23552
    s_add_u32 m0, s31, 32768
    s_add_u32 s49, s30, 176128
    buffer_load_dwordx4 v1, s[40:43], s49 offen offset:0 sc1 lds
    v_fma_f32 v145, v145, v11, v11
    v_mfma_f32_32x32x16_bf16 v[192:207], a[244:247], v[84:87], v[192:207]
    ds_read_b128 a[240:243], v6 offset:24576
    v_exp_f32 v148, v148
    v_fma_f32 v146, v146, v11, v11
    v_exp_f32 v149, v149
    v_fma_f32 v147, v147, v11, v11
    s_mul_i32 s13, s13, 114688
    s_waitcnt lgkmcnt(5)
    v_mfma_f32_32x32x16_bf16 v[192:207], a[248:251], v[88:91], v[192:207]
    ds_read_b128 a[244:247], v6 offset:25600
    buffer_load_dwordx4 v1, s[40:43], s49 offen offset:1024 sc1 lds
    v_exp_f32 v150, v150
    v_fma_f32 v148, v148, v11, v11
    v_mfma_f32_32x32x16_bf16 v[192:207], a[252:255], v[92:95], v[192:207]
    ds_read_b128 a[248:251], v6 offset:26624
    v_exp_f32 v151, v151
    v_fma_f32 v149, v149, v11, v11
    v_fma_f32 v150, v150, v11, v11
    v_fma_f32 v151, v151, v11, v11
    v_rcp_f32 v144, v144
    s_add_u32 s68, s13, s14
    s_waitcnt lgkmcnt(5)
    v_mfma_f32_32x32x16_bf16 v[192:207], a[224:227], v[96:99], v[192:207]
    ds_read_b128 a[252:255], v6 offset:27648
    buffer_load_dwordx4 v1, s[40:43], s49 offen offset:2048 sc1 lds
    v_rcp_f32 v145, v145
    v_mfma_f32_32x32x16_bf16 v[192:207], a[228:231], v[100:103], v[192:207]
    ds_read_b128 a[224:227], v7 offset:2048
    v_rcp_f32 v146, v146
    v_mul_f32 v144, v144, v152
    v_rcp_f32 v147, v147
    v_mul_f32 v145, v145, v153
    v_rcp_f32 v148, v148
    s_add_u32 s69, s68, 4096
    s_waitcnt lgkmcnt(5)
    v_mfma_f32_32x32x16_bf16 v[192:207], a[232:235], v[104:107], v[192:207]
    s_waitcnt vmcnt(8)
    s_barrier
    ds_read_b128 a[228:231], v1 offset:0
    v_mul_f32 v146, v146, v154
    v_rcp_f32 v149, v149
    v_mul_f32 v147, v147, v155
    v_rcp_f32 v150, v150
    v_mfma_f32_32x32x16_bf16 v[192:207], a[236:239], v[108:111], v[192:207]
    ds_read_b128 a[232:235], v1 offset:1024
    v_mul_f32 v148, v148, v156
    v_rcp_f32 v151, v151
    v_mul_f32 v149, v149, v157
    v_mul_f32 v150, v150, v158
    v_mul_f32 v151, v151, v159
    s_add_u32 s70, s68, 8192
    s_waitcnt lgkmcnt(5)
    v_mfma_f32_32x32x16_bf16 v[192:207], a[240:243], v[112:115], v[192:207]
    ds_read_b128 a[236:239], v1 offset:2048
    buffer_load_dwordx4 a[164:167], v249, s[40:43], s48 offen sc1
    v_cvt_pk_bf16_f32 v236, v144, v145
    v_cvt_pk_bf16_f32 v237, v146, v147
    v_cvt_pk_bf16_f32 v238, v148, v149
    v_pk_mul_f32 v[224:225], v[160:161], v[160:161]
    v_pk_mul_f32 v[226:227], v[162:163], v[162:163]
    v_pk_mul_f32 v[228:229], v[164:165], v[164:165]
    v_pk_mul_f32 v[230:231], v[166:167], v[166:167]
    v_pk_fma_f32 v[224:225], v[224:225], v[10:11], v[8:9] op_sel:[0,0,1] op_sel_hi:[1,0,1]
    v_pk_fma_f32 v[226:227], v[226:227], v[10:11], v[8:9] op_sel:[0,0,1] op_sel_hi:[1,0,1]
    v_pk_fma_f32 v[228:229], v[228:229], v[10:11], v[8:9] op_sel:[0,0,1] op_sel_hi:[1,0,1]
    v_pk_fma_f32 v[230:231], v[230:231], v[10:11], v[8:9] op_sel:[0,0,1] op_sel_hi:[1,0,1]
    v_pk_mul_f32 v[168:169], v[160:161], v[168:169]
    v_pk_mul_f32 v[170:171], v[162:163], v[170:171]
    v_pk_mul_f32 v[172:173], v[164:165], v[172:173]
    v_pk_mul_f32 v[174:175], v[166:167], v[174:175]
    v_pk_mul_f32 v[160:161], v[224:225], v[160:161]
    v_pk_mul_f32 v[162:163], v[226:227], v[162:163]
    v_pk_mul_f32 v[164:165], v[228:229], v[164:165]
    v_pk_mul_f32 v[166:167], v[230:231], v[166:167]
    v_mfma_f32_32x32x16_bf16 v[192:207], a[244:247], v[116:119], v[192:207]
    ds_read_b128 a[240:243], v1 offset:3072
    v_cvt_pk_bf16_f32 v239, v150, v151
    buffer_store_dwordx4 v[236:239], v1, s[40:43], s29 offen offset:1024 sc1
    v_exp_f32 v160, v160
    s_add_u32 s71, s68, 12288
    s_waitcnt lgkmcnt(5)
    v_mfma_f32_32x32x16_bf16 v[192:207], a[248:251], v[120:123], v[192:207]
    ds_read_b128 a[244:247], v1 offset:4096
    s_add_u32 s48, s48, 14336
    buffer_load_dwordx4 a[168:171], v248, s[40:43], s48 offen sc1
    v_exp_f32 v161, v161
    v_mfma_f32_32x32x16_bf16 v[192:207], a[252:255], v[124:127], v[192:207]
    ds_read_b128 a[248:251], v1 offset:5120
    v_exp_f32 v162, v162
    v_fma_f32 v160, v160, v11, v11
    v_exp_f32 v163, v163
    v_fma_f32 v161, v161, v11, v11
    v_exp_f32 v164, v164
    s_add_u32 s72, s68, 16384
    s_waitcnt lgkmcnt(5)
    v_mfma_f32_32x32x16_bf16 v[192:207], a[224:227], v[208:211], v[192:207]
    ds_read_b128 a[252:255], v1 offset:6144
    v_fma_f32 v162, v162, v11, v11
    v_exp_f32 v165, v165
    v_fma_f32 v163, v163, v11, v11
    v_mfma_f32_32x32x16_bf16 v[128:143], a[228:231], v[16:19], 0
    ds_read_b128 a[224:227], v1 offset:7168
    buffer_load_dwordx4 a[172:175], v249, s[40:43], s48 offen sc1
    v_exp_f32 v166, v166
    v_fma_f32 v164, v164, v11, v11
    v_exp_f32 v167, v167
    s_add_u32 s73, s68, 20480
    s_waitcnt lgkmcnt(5)
    v_mfma_f32_32x32x16_bf16 v[128:143], a[232:235], v[20:23], v[128:143]
    ds_read_b128 a[228:231], v1 offset:8192
    v_fma_f32 v165, v165, v11, v11
    v_fma_f32 v166, v166, v11, v11
    v_fma_f32 v167, v167, v11, v11
    v_rcp_f32 v160, v160
    v_mfma_f32_32x32x16_bf16 v[128:143], a[236:239], v[24:27], v[128:143]
    ds_read_b128 a[232:235], v1 offset:9216
    v_rcp_f32 v161, v161
    v_rcp_f32 v162, v162
    v_mul_f32 v160, v160, v168
    v_rcp_f32 v163, v163
    s_add_u32 s74, s68, 24576
    s_waitcnt lgkmcnt(5)
    v_mfma_f32_32x32x16_bf16 v[128:143], a[240:243], v[28:31], v[128:143]
    ds_read_b128 a[236:239], v1 offset:10240
    s_add_u32 s48, s48, 14336
    buffer_load_dwordx4 a[176:179], v248, s[40:43], s48 offen sc1
    v_mul_f32 v161, v161, v169
    v_rcp_f32 v164, v164
    v_mfma_f32_32x32x16_bf16 v[128:143], a[244:247], v[32:35], v[128:143]
    ds_read_b128 a[240:243], v1 offset:11264
    v_mul_f32 v162, v162, v170
    v_rcp_f32 v165, v165
    v_mul_f32 v163, v163, v171
    v_rcp_f32 v166, v166
    s_mul_i32 s12, s12, 114688
    s_waitcnt lgkmcnt(5)
    v_mfma_f32_32x32x16_bf16 v[128:143], a[248:251], v[36:39], v[128:143]
    ds_read_b128 a[244:247], v1 offset:12288
    v_mul_f32 v164, v164, v172
    v_rcp_f32 v167, v167
    v_mul_f32 v165, v165, v173
    v_mul_f32 v166, v166, v174
    v_mul_f32 v167, v167, v175
    v_mfma_f32_32x32x16_bf16 v[128:143], a[252:255], v[40:43], v[128:143]
    ds_read_b128 a[248:251], v1 offset:13312
    buffer_load_dwordx4 a[180:183], v249, s[40:43], s48 offen sc1
    v_cvt_pk_bf16_f32 v232, v160, v161
    v_cvt_pk_bf16_f32 v233, v162, v163
    v_cvt_pk_bf16_f32 v234, v164, v165
    s_add_u32 s76, s12, s14
    s_waitcnt lgkmcnt(5)
    v_pk_mul_f32 v[224:225], v[176:177], v[176:177]
    v_pk_mul_f32 v[226:227], v[178:179], v[178:179]
    v_pk_mul_f32 v[228:229], v[180:181], v[180:181]
    v_pk_mul_f32 v[230:231], v[182:183], v[182:183]
    v_pk_fma_f32 v[224:225], v[224:225], v[10:11], v[8:9] op_sel:[0,0,1] op_sel_hi:[1,0,1]
    v_pk_fma_f32 v[226:227], v[226:227], v[10:11], v[8:9] op_sel:[0,0,1] op_sel_hi:[1,0,1]
    v_pk_fma_f32 v[228:229], v[228:229], v[10:11], v[8:9] op_sel:[0,0,1] op_sel_hi:[1,0,1]
    v_pk_fma_f32 v[230:231], v[230:231], v[10:11], v[8:9] op_sel:[0,0,1] op_sel_hi:[1,0,1]
    v_pk_mul_f32 v[184:185], v[176:177], v[184:185]
    v_pk_mul_f32 v[186:187], v[178:179], v[186:187]
    v_pk_mul_f32 v[188:189], v[180:181], v[188:189]
    v_pk_mul_f32 v[190:191], v[182:183], v[190:191]
    v_pk_mul_f32 v[176:177], v[224:225], v[176:177]
    v_pk_mul_f32 v[178:179], v[226:227], v[178:179]
    v_pk_mul_f32 v[180:181], v[228:229], v[180:181]
    v_pk_mul_f32 v[182:183], v[230:231], v[182:183]
    v_mfma_f32_32x32x16_bf16 v[128:143], a[224:227], v[44:47], v[128:143]
    ds_read_b128 a[252:255], v1 offset:14336
    v_cvt_pk_bf16_f32 v235, v166, v167
    buffer_store_dwordx4 v[232:235], v1, s[40:43], s29 offen offset:2048 sc1
    v_exp_f32 v176, v176
    v_mfma_f32_32x32x16_bf16 v[128:143], a[228:231], v[48:51], v[128:143]
    ds_read_b128 a[224:227], v1 offset:15360
    v_exp_f32 v177, v177
    v_exp_f32 v178, v178
    v_fma_f32 v176, v176, v11, v11
    v_exp_f32 v179, v179
    s_add_u32 s77, s76, 4096
    s_waitcnt lgkmcnt(5)
    v_mfma_f32_32x32x16_bf16 v[128:143], a[232:235], v[52:55], v[128:143]
    ds_read_b128 a[228:231], v1 offset:16384
    s_add_u32 s48, s48, 14336
    buffer_load_dwordx4 a[184:187], v248, s[40:43], s48 offen sc1
    v_fma_f32 v177, v177, v11, v11
    v_mfma_f32_32x32x16_bf16 v[128:143], a[236:239], v[56:59], v[128:143]
    ds_read_b128 a[232:235], v1 offset:17408
    v_exp_f32 v180, v180
    v_fma_f32 v178, v178, v11, v11
    v_exp_f32 v181, v181
    v_fma_f32 v179, v179, v11, v11
    v_exp_f32 v182, v182
    s_add_u32 s78, s76, 8192
    s_waitcnt lgkmcnt(5)
    v_mfma_f32_32x32x16_bf16 v[128:143], a[240:243], v[60:63], v[128:143]
    ds_read_b128 a[236:239], v1 offset:18432
    buffer_load_dwordx4 a[188:191], v249, s[40:43], s48 offen sc1
    v_fma_f32 v180, v180, v11, v11
    v_exp_f32 v183, v183
    v_mfma_f32_32x32x16_bf16 v[128:143], a[244:247], v[64:67], v[128:143]
    ds_read_b128 a[240:243], v1 offset:19456
    v_fma_f32 v181, v181, v11, v11
    v_fma_f32 v182, v182, v11, v11
    v_fma_f32 v183, v183, v11, v11
    v_rcp_f32 v176, v176
    s_add_u32 s79, s76, 12288
    s_waitcnt lgkmcnt(5)
    v_mfma_f32_32x32x16_bf16 v[128:143], a[248:251], v[68:71], v[128:143]
    ds_read_b128 a[244:247], v1 offset:20480
    v_rcp_f32 v177, v177
    v_rcp_f32 v178, v178
    v_mul_f32 v176, v176, v184
    v_rcp_f32 v179, v179
    v_mfma_f32_32x32x16_bf16 v[128:143], a[252:255], v[72:75], v[128:143]
    ds_read_b128 a[248:251], v1 offset:21504
    s_sub_u32 s48, s48, 40960
    buffer_load_dwordx4 a[192:195], v248, s[40:43], s48 offen sc1
    v_mul_f32 v177, v177, v185
    v_rcp_f32 v180, v180
    s_add_u32 s80, s76, 16384
    s_waitcnt lgkmcnt(5)
    v_mfma_f32_32x32x16_bf16 v[128:143], a[224:227], v[76:79], v[128:143]
    ds_read_b128 a[252:255], v1 offset:22528
    v_mul_f32 v178, v178, v186
    v_rcp_f32 v181, v181
    v_mul_f32 v179, v179, v187
    v_rcp_f32 v182, v182
    v_mfma_f32_32x32x16_bf16 v[128:143], a[228:231], v[80:83], v[128:143]
    ds_read_b128 a[224:227], v1 offset:23552
    v_mul_f32 v180, v180, v188
    v_rcp_f32 v183, v183
    v_mul_f32 v181, v181, v189
    v_mul_f32 v182, v182, v190
    v_mul_f32 v183, v183, v191
    s_add_u32 s81, s76, 20480
    s_waitcnt lgkmcnt(5)
    v_mfma_f32_32x32x16_bf16 v[128:143], a[232:235], v[84:87], v[128:143]
    ds_read_b128 a[228:231], v1 offset:24576
    buffer_load_dwordx4 a[196:199], v249, s[40:43], s48 offen sc1
    v_cvt_pk_bf16_f32 v236, v176, v177
    v_cvt_pk_bf16_f32 v237, v178, v179
    v_cvt_pk_bf16_f32 v238, v180, v181
    v_pk_mul_f32 v[224:225], v[192:193], v[192:193]
    v_pk_mul_f32 v[226:227], v[194:195], v[194:195]
    v_pk_mul_f32 v[228:229], v[196:197], v[196:197]
    v_pk_mul_f32 v[230:231], v[198:199], v[198:199]
    v_pk_fma_f32 v[224:225], v[224:225], v[10:11], v[8:9] op_sel:[0,0,1] op_sel_hi:[1,0,1]
    v_pk_fma_f32 v[226:227], v[226:227], v[10:11], v[8:9] op_sel:[0,0,1] op_sel_hi:[1,0,1]
    v_pk_fma_f32 v[228:229], v[228:229], v[10:11], v[8:9] op_sel:[0,0,1] op_sel_hi:[1,0,1]
    v_pk_fma_f32 v[230:231], v[230:231], v[10:11], v[8:9] op_sel:[0,0,1] op_sel_hi:[1,0,1]
    v_pk_mul_f32 v[200:201], v[192:193], v[200:201]
    v_pk_mul_f32 v[202:203], v[194:195], v[202:203]
    v_pk_mul_f32 v[204:205], v[196:197], v[204:205]
    v_pk_mul_f32 v[206:207], v[198:199], v[206:207]
    v_pk_mul_f32 v[192:193], v[224:225], v[192:193]
    v_pk_mul_f32 v[194:195], v[226:227], v[194:195]
    v_pk_mul_f32 v[196:197], v[228:229], v[196:197]
    v_pk_mul_f32 v[198:199], v[230:231], v[198:199]
    v_mfma_f32_32x32x16_bf16 v[128:143], a[236:239], v[88:91], v[128:143]
    ds_read_b128 a[232:235], v1 offset:25600
    v_cvt_pk_bf16_f32 v239, v182, v183
    buffer_store_dwordx4 v[236:239], v1, s[40:43], s29 offen offset:3072 sc1
    v_exp_f32 v192, v192
    s_add_u32 s82, s76, 24576
    s_waitcnt lgkmcnt(5)
    v_mfma_f32_32x32x16_bf16 v[128:143], a[240:243], v[92:95], v[128:143]
    ds_read_b128 a[236:239], v1 offset:26624
    v_exp_f32 v193, v193
    v_exp_f32 v194, v194
    v_fma_f32 v192, v192, v11, v11
    v_exp_f32 v195, v195
    v_mfma_f32_32x32x16_bf16 v[128:143], a[244:247], v[96:99], v[128:143]
    ds_read_b128 a[240:243], v1 offset:27648
    s_add_u32 s48, s48, 14336
    buffer_load_dwordx4 a[200:203], v248, s[40:43], s48 offen sc1
    v_fma_f32 v193, v193, v11, v11
    v_exp_f32 v196, v196
    s_waitcnt lgkmcnt(5)
    v_mfma_f32_32x32x16_bf16 v[128:143], a[248:251], v[100:103], v[128:143]
    ds_read_b128 a[244:247], v7 offset:2560
    v_fma_f32 v194, v194, v11, v11
    v_exp_f32 v197, v197
    v_fma_f32 v195, v195, v11, v11
    v_exp_f32 v198, v198
    v_mfma_f32_32x32x16_bf16 v[128:143], a[252:255], v[104:107], v[128:143]
    s_waitcnt vmcnt(13)
    s_barrier
    ds_read_b128 a[248:251], v1 offset:28672
    v_fma_f32 v196, v196, v11, v11
    v_exp_f32 v199, v199
    v_fma_f32 v197, v197, v11, v11
    v_fma_f32 v198, v198, v11, v11
    v_fma_f32 v199, v199, v11, v11
    s_waitcnt lgkmcnt(5)
    v_mfma_f32_32x32x16_bf16 v[128:143], a[224:227], v[108:111], v[128:143]
    ds_read_b128 a[252:255], v1 offset:29696
    buffer_load_dwordx4 a[204:207], v249, s[40:43], s48 offen sc1
    s_waitcnt vmcnt(7)
    s_mov_b32 s11, s27
    s_lshl_b32 s11, s11, 10
    s_add_u32 s11, s11, 23472128
    s_mov_b64 exec, 0xffff
    buffer_store_dwordx4 v[250:253], v1, s[40:43], s11 offen sc1
    s_mov_b64 exec, -1
    v_mfma_f32_32x32x16_bf16 v[128:143], a[228:231], v[112:115], v[128:143]
    ds_read_b128 a[224:227], v1 offset:30720
    v_rcp_f32 v192, v192
    s_waitcnt lgkmcnt(5)
    v_mfma_f32_32x32x16_bf16 v[128:143], a[232:235], v[116:119], v[128:143]
    ds_read_b128 a[228:231], v1 offset:31744
    s_add_u32 s48, s48, 14336
    buffer_load_dwordx4 a[208:211], v248, s[40:43], s48 offen sc1
    v_rcp_f32 v193, v193
    v_rcp_f32 v194, v194
    v_mfma_f32_32x32x16_bf16 v[128:143], a[236:239], v[120:123], v[128:143]
    ds_read_b128 a[232:235], v1 offset:32768
    v_mul_f32 v192, v192, v200
    v_rcp_f32 v195, v195
    v_mul_f32 v193, v193, v201
    v_rcp_f32 v196, v196
    v_mul_f32 v194, v194, v202
    s_waitcnt lgkmcnt(5)
    v_mfma_f32_32x32x16_bf16 v[128:143], a[240:243], v[124:127], v[128:143]
    ds_read_b128 a[236:239], v1 offset:33792
    v_rcp_f32 v197, v197
    v_mul_f32 v195, v195, v203
    v_rcp_f32 v198, v198
    v_mul_f32 v196, v196, v204
    v_mfma_f32_32x32x16_bf16 v[128:143], a[244:247], v[208:211], v[128:143]
    ds_read_b128 a[240:243], v1 offset:34816
    buffer_load_dwordx4 a[212:215], v249, s[40:43], s48 offen sc1
    v_rcp_f32 v199, v199
    v_mul_f32 v197, v197, v205
    v_mul_f32 v198, v198, v206
    v_mul_f32 v199, v199, v207
    s_waitcnt lgkmcnt(5)
    v_mfma_f32_32x32x16_bf16 v[144:159], a[248:251], v[16:19], 0
    ds_read_b128 a[244:247], v1 offset:35840
    v_cvt_pk_bf16_f32 v232, v192, v193
    v_cvt_pk_bf16_f32 v233, v194, v195
    v_cvt_pk_bf16_f32 v234, v196, v197
    v_cvt_pk_bf16_f32 v235, v198, v199
    buffer_store_dwordx4 v[232:235], v1, s[40:43], s28 offen offset:0 sc1
    v_mfma_f32_32x32x16_bf16 v[144:159], a[252:255], v[20:23], v[144:159]
    ds_read_b128 a[248:251], v1 offset:36864
    s_waitcnt lgkmcnt(5)
    v_pk_mul_f32 v[224:225], v[128:129], v[128:129]
    v_pk_mul_f32 v[226:227], v[130:131], v[130:131]
    v_pk_mul_f32 v[228:229], v[132:133], v[132:133]
    v_pk_mul_f32 v[230:231], v[134:135], v[134:135]
    v_pk_fma_f32 v[224:225], v[224:225], v[10:11], v[8:9] op_sel:[0,0,1] op_sel_hi:[1,0,1]
    v_pk_fma_f32 v[226:227], v[226:227], v[10:11], v[8:9] op_sel:[0,0,1] op_sel_hi:[1,0,1]
    v_pk_fma_f32 v[228:229], v[228:229], v[10:11], v[8:9] op_sel:[0,0,1] op_sel_hi:[1,0,1]
    v_pk_fma_f32 v[230:231], v[230:231], v[10:11], v[8:9] op_sel:[0,0,1] op_sel_hi:[1,0,1]
    v_pk_mul_f32 v[136:137], v[128:129], v[136:137]
    v_pk_mul_f32 v[138:139], v[130:131], v[138:139]
    v_pk_mul_f32 v[140:141], v[132:133], v[140:141]
    v_pk_mul_f32 v[142:143], v[134:135], v[142:143]
    v_pk_mul_f32 v[128:129], v[224:225], v[128:129]
    v_pk_mul_f32 v[130:131], v[226:227], v[130:131]
    v_pk_mul_f32 v[132:133], v[228:229], v[132:133]
    v_pk_mul_f32 v[134:135], v[230:231], v[134:135]
    v_mfma_f32_32x32x16_bf16 v[144:159], a[224:227], v[24:27], v[144:159]
    ds_read_b128 a[252:255], v1 offset:37888
    s_add_u32 s48, s48, 14336
    buffer_load_dwordx4 a[216:219], v248, s[40:43], s48 offen sc1
    v_exp_f32 v128, v128
    v_exp_f32 v129, v129
    v_exp_f32 v130, v130
    v_fma_f32 v128, v128, v11, v11
    v_exp_f32 v131, v131
    v_mfma_f32_32x32x16_bf16 v[144:159], a[228:231], v[28:31], v[144:159]
    ds_read_b128 a[224:227], v1 offset:38912
    v_fma_f32 v129, v129, v11, v11
    v_exp_f32 v132, v132
    v_fma_f32 v130, v130, v11, v11
    v_exp_f32 v133, v133
    s_waitcnt lgkmcnt(5)
    v_mfma_f32_32x32x16_bf16 v[144:159], a[232:235], v[32:35], v[144:159]
    ds_read_b128 a[228:231], v1 offset:39936
    v_fma_f32 v131, v131, v11, v11
    v_exp_f32 v134, v134
    v_fma_f32 v132, v132, v11, v11
    v_exp_f32 v135, v135
    v_fma_f32 v133, v133, v11, v11
    v_mfma_f32_32x32x16_bf16 v[144:159], a[236:239], v[36:39], v[144:159]
    ds_read_b128 a[232:235], v1 offset:40960
    buffer_load_dwordx4 a[220:223], v249, s[40:43], s48 offen sc1
    v_fma_f32 v134, v134, v11, v11
    v_fma_f32 v135, v135, v11, v11
    v_rcp_f32 v128, v128
    s_waitcnt lgkmcnt(5)
    v_mfma_f32_32x32x16_bf16 v[144:159], a[240:243], v[40:43], v[144:159]
    ds_read_b128 a[236:239], v1 offset:41984
    v_rcp_f32 v129, v129
    v_rcp_f32 v130, v130
    v_mul_f32 v128, v128, v136
    v_rcp_f32 v131, v131
    v_mfma_f32_32x32x16_bf16 v[144:159], a[244:247], v[44:47], v[144:159]
    ds_read_b128 a[240:243], v1 offset:43008
    v_mul_f32 v129, v129, v137
    v_rcp_f32 v132, v132
    v_mul_f32 v130, v130, v138
    v_rcp_f32 v133, v133
    s_waitcnt lgkmcnt(5)
    v_mfma_f32_32x32x16_bf16 v[144:159], a[248:251], v[48:51], v[144:159]
    ds_read_b128 a[244:247], v1 offset:44032
    v_mul_f32 v131, v131, v139
    v_rcp_f32 v134, v134
    v_mul_f32 v132, v132, v140
    v_rcp_f32 v135, v135
    v_mul_f32 v133, v133, v141
    v_mfma_f32_32x32x16_bf16 v[144:159], a[252:255], v[52:55], v[144:159]
    ds_read_b128 a[248:251], v1 offset:45056
    v_mul_f32 v134, v134, v142
    v_mul_f32 v135, v135, v143
    v_cvt_pk_bf16_f32 v236, v128, v129
    v_cvt_pk_bf16_f32 v237, v130, v131
    v_cvt_pk_bf16_f32 v238, v132, v133
    v_cvt_pk_bf16_f32 v239, v134, v135
    s_waitcnt lgkmcnt(5)
    v_mfma_f32_32x32x16_bf16 v[144:159], a[224:227], v[56:59], v[144:159]
    ds_read_b128 a[252:255], v1 offset:46080
    buffer_store_dwordx4 v[236:239], v1, s[40:43], s28 offen offset:1024 sc1
    v_mfma_f32_32x32x16_bf16 v[144:159], a[228:231], v[60:63], v[144:159]
    ds_read_b128 a[224:227], v1 offset:47104
    s_waitcnt lgkmcnt(5)
    v_mfma_f32_32x32x16_bf16 v[144:159], a[232:235], v[64:67], v[144:159]
    ds_read_b128 a[228:231], v1 offset:48128
    v_mfma_f32_32x32x16_bf16 v[144:159], a[236:239], v[68:71], v[144:159]
    ds_read_b128 a[232:235], v1 offset:49152
    s_waitcnt lgkmcnt(5)
    v_mfma_f32_32x32x16_bf16 v[144:159], a[240:243], v[72:75], v[144:159]
    ds_read_b128 a[236:239], v1 offset:50176
    v_mfma_f32_32x32x16_bf16 v[144:159], a[244:247], v[76:79], v[144:159]
    ds_read_b128 a[240:243], v1 offset:51200
    s_waitcnt lgkmcnt(5)
    v_mfma_f32_32x32x16_bf16 v[144:159], a[248:251], v[80:83], v[144:159]
    ds_read_b128 a[244:247], v1 offset:52224
    v_mfma_f32_32x32x16_bf16 v[144:159], a[252:255], v[84:87], v[144:159]
    ds_read_b128 a[248:251], v1 offset:53248
    s_waitcnt lgkmcnt(5)
    v_mfma_f32_32x32x16_bf16 v[144:159], a[224:227], v[88:91], v[144:159]
    ds_read_b128 a[252:255], v1 offset:54272
    v_mfma_f32_32x32x16_bf16 v[144:159], a[228:231], v[92:95], v[144:159]
    ds_read_b128 a[224:227], v1 offset:55296
    s_waitcnt lgkmcnt(5)
    v_mfma_f32_32x32x16_bf16 v[144:159], a[232:235], v[96:99], v[144:159]
    ds_read_b128 a[228:231], v1 offset:56320
    v_mfma_f32_32x32x16_bf16 v[144:159], a[236:239], v[100:103], v[144:159]
    ds_read_b128 a[232:235], v7 offset:3072
    s_waitcnt lgkmcnt(5)
    v_mfma_f32_32x32x16_bf16 v[144:159], a[240:243], v[104:107], v[144:159]
    v_mfma_f32_32x32x16_bf16 v[144:159], a[244:247], v[108:111], v[144:159]
    s_waitcnt lgkmcnt(3)
    v_mfma_f32_32x32x16_bf16 v[144:159], a[248:251], v[112:115], v[144:159]
    s_waitcnt lgkmcnt(0)
    s_load_dword s52, s[34:35], s20 offset:0
    s_load_dword s53, s[34:35], s20 offset:1024
    s_load_dword s54, s[34:35], s20 offset:2048
    s_load_dword s55, s[34:35], s20 offset:3072
    s_load_dword s56, s[34:35], s20 offset:16384
    s_load_dword s57, s[34:35], s20 offset:17408
    s_load_dword s58, s[34:35], s20 offset:18432
    s_load_dword s59, s[34:35], s20 offset:19456
    v_mfma_f32_32x32x16_bf16 v[144:159], a[252:255], v[116:119], v[144:159]
    v_mfma_f32_32x32x16_bf16 v[144:159], a[224:227], v[120:123], v[144:159]
    s_waitcnt vmcnt(0)
    s_mov_b32 s11, s27
    s_lshl_b32 s11, s11, 10
    s_add_u32 s11, s11, 23472384
    s_mov_b64 exec, 0xffff
    buffer_store_dwordx4 v[250:253], v1, s[40:43], s11 offen sc1
    s_mov_b64 exec, -1
    v_mfma_f32_32x32x16_bf16 v[144:159], a[228:231], v[124:127], v[144:159]
    v_mfma_f32_32x32x16_bf16 v[144:159], a[232:235], v[208:211], v[144:159]
    s_cmp_ge_u32 s7, 7
    s_cbranch_scc1 L_idle5
    s_waitcnt lgkmcnt(0)
    s_xor_b64 s[52:53], s[52:53], s[50:51]
    s_xor_b64 s[54:55], s[54:55], s[50:51]
    s_or_b64 s[52:53], s[52:53], s[54:55]
    s_xor_b64 s[56:57], s[56:57], s[50:51]
    s_or_b64 s[52:53], s[52:53], s[56:57]
    s_xor_b64 s[58:59], s[58:59], s[50:51]
    s_or_b64 s[52:53], s[52:53], s[58:59]
    s_cbranch_scc1 L_p5slow
    buffer_load_dwordx4 v[160:163], v1, s[40:43], s68 offen offset:0 sc1
    v_pk_mul_f32 v[224:225], v[144:145], v[144:145]
    v_pk_mul_f32 v[226:227], v[146:147], v[146:147]
    v_pk_mul_f32 v[228:229], v[148:149], v[148:149]
    v_pk_mul_f32 v[230:231], v[150:151], v[150:151]
    v_pk_fma_f32 v[224:225], v[224:225], v[10:11], v[8:9] op_sel:[0,0,1] op_sel_hi:[1,0,1]
    buffer_load_dwordx4 v[164:167], v1, s[40:43], s76 offen offset:0 sc1
    v_pk_fma_f32 v[226:227], v[226:227], v[10:11], v[8:9] op_sel:[0,0,1] op_sel_hi:[1,0,1]
    v_pk_fma_f32 v[228:229], v[228:229], v[10:11], v[8:9] op_sel:[0,0,1] op_sel_hi:[1,0,1]
    v_pk_fma_f32 v[230:231], v[230:231], v[10:11], v[8:9] op_sel:[0,0,1] op_sel_hi:[1,0,1]
    v_pk_mul_f32 v[152:153], v[144:145], v[152:153]
    v_pk_mul_f32 v[154:155], v[146:147], v[154:155]
    buffer_load_dwordx4 v[168:171], v1, s[40:43], s69 offen offset:3072 sc1
    v_pk_mul_f32 v[156:157], v[148:149], v[156:157]
    v_pk_mul_f32 v[158:159], v[150:151], v[158:159]
    v_pk_mul_f32 v[144:145], v[224:225], v[144:145]
    v_pk_mul_f32 v[146:147], v[226:227], v[146:147]
    v_pk_mul_f32 v[148:149], v[228:229], v[148:149]
    buffer_load_dwordx4 v[172:175], v1, s[40:43], s77 offen offset:3072 sc1
    v_pk_mul_f32 v[150:151], v[230:231], v[150:151]
    v_exp_f32 v144, v144
    v_exp_f32 v145, v145
    v_exp_f32 v146, v146
    v_exp_f32 v147, v147
    buffer_load_dwordx4 v[176:179], v1, s[40:43], s71 offen offset:2048 sc1
    v_exp_f32 v148, v148
    v_exp_f32 v149, v149
    v_exp_f32 v150, v150
    v_exp_f32 v151, v151
    v_pk_fma_f32 v[144:145], v[144:145], v[10:11], v[10:11] op_sel:[0,1,1] op_sel_hi:[1,1,1]
    buffer_load_dwordx4 v[180:183], v1, s[40:43], s79 offen offset:2048 sc1
    v_pk_fma_f32 v[146:147], v[146:147], v[10:11], v[10:11] op_sel:[0,1,1] op_sel_hi:[1,1,1]
    v_pk_fma_f32 v[148:149], v[148:149], v[10:11], v[10:11] op_sel:[0,1,1] op_sel_hi:[1,1,1]
    v_pk_fma_f32 v[150:151], v[150:151], v[10:11], v[10:11] op_sel:[0,1,1] op_sel_hi:[1,1,1]
    v_rcp_f32 v144, v144
    v_rcp_f32 v145, v145
    buffer_load_dwordx4 v[184:187], v1, s[40:43], s73 offen offset:1024 sc1
    v_rcp_f32 v146, v146
    v_rcp_f32 v147, v147
    v_rcp_f32 v148, v148
    v_rcp_f32 v149, v149
    v_rcp_f32 v150, v150
    buffer_load_dwordx4 v[188:191], v1, s[40:43], s81 offen offset:1024 sc1
    v_rcp_f32 v151, v151
    v_pk_mul_f32 v[144:145], v[144:145], v[152:153]
    v_pk_mul_f32 v[146:147], v[146:147], v[154:155]
    v_pk_mul_f32 v[148:149], v[148:149], v[156:157]
    v_pk_mul_f32 v[150:151], v[150:151], v[158:159]
    v_cvt_pk_bf16_f32 v232, v144, v145
    v_cvt_pk_bf16_f32 v233, v146, v147
    v_cvt_pk_bf16_f32 v234, v148, v149
    v_cvt_pk_bf16_f32 v235, v150, v151
    buffer_store_dwordx4 v[232:235], v1, s[40:43], s28 offen offset:2048 sc1
L_p5join:
    v_lshlrev_b32 v16, 16, v240
    v_and_b32 v17, 0xffff0000, v240
    v_lshlrev_b32 v18, 16, v241
    v_and_b32 v19, 0xffff0000, v241
    v_lshlrev_b32 v20, 16, v242
    v_and_b32 v21, 0xffff0000, v242
    v_lshlrev_b32 v22, 16, v243
    v_and_b32 v23, 0xffff0000, v243
    v_lshlrev_b32 v24, 16, v244
    v_and_b32 v25, 0xffff0000, v244
    v_lshlrev_b32 v26, 16, v245
    v_and_b32 v27, 0xffff0000, v245
    v_lshlrev_b32 v28, 16, v246
    v_and_b32 v29, 0xffff0000, v246
    v_lshlrev_b32 v30, 16, v247
    v_and_b32 v31, 0xffff0000, v247
    buffer_load_dwordx4 v[192:195], v1, s[40:43], s68 offen offset:1024 sc1
    buffer_load_dwordx4 v[196:199], v1, s[40:43], s76 offen offset:1024 sc1
    buffer_load_dwordx4 v[200:203], v1, s[40:43], s70 offen offset:0 sc1
    buffer_load_dwordx4 v[204:207], v1, s[40:43], s78 offen offset:0 sc1
    buffer_load_dwordx4 v[80:83], v1, s[40:43], s71 offen offset:3072 sc1
    buffer_load_dwordx4 v[84:87], v1, s[40:43], s79 offen offset:3072 sc1
    s_waitcnt vmcnt(14)
    v_mfma_f32_32x32x16_bf16 v[16:31], a[0:3], v[160:163], v[16:31]
    v_mfma_f32_32x32x16_bf16 v[48:63], a[4:7], v[160:163], 0
    buffer_load_dwordx4 v[88:91], v1, s[40:43], s73 offen offset:2048 sc1
    s_waitcnt vmcnt(14)
    v_mfma_f32_32x32x16_bf16 v[32:47], a[0:3], v[164:167], 0
    v_mfma_f32_32x32x16_bf16 v[64:79], a[4:7], v[164:167], 0
    buffer_load_dwordx4 v[92:95], v1, s[40:43], s81 offen offset:2048 sc1
    s_waitcnt vmcnt(14)
    v_mfma_f32_32x32x16_bf16 v[16:31], a[8:11], v[168:171], v[16:31]
    v_mfma_f32_32x32x16_bf16 v[48:63], a[12:15], v[168:171], v[48:63]
    buffer_load_dwordx4 v[96:99], v1, s[40:43], s68 offen offset:2048 sc1
    s_waitcnt vmcnt(14)
    v_mfma_f32_32x32x16_bf16 v[32:47], a[8:11], v[172:175], v[32:47]
    v_mfma_f32_32x32x16_bf16 v[64:79], a[12:15], v[172:175], v[64:79]
    buffer_load_dwordx4 v[100:103], v1, s[40:43], s76 offen offset:2048 sc1
    s_load_dword s52, s[34:35], s20 offset:256
    s_load_dword s53, s[34:35], s20 offset:1280
    s_load_dword s54, s[34:35], s20 offset:2304
    s_load_dword s55, s[34:35], s20 offset:3328
    s_load_dword s56, s[34:35], s20 offset:16640
    s_load_dword s57, s[34:35], s20 offset:17664
    s_load_dword s58, s[34:35], s20 offset:18688
    s_load_dword s59, s[34:35], s20 offset:19712
    s_waitcnt vmcnt(14)
    v_mfma_f32_32x32x16_bf16 v[16:31], a[16:19], v[176:179], v[16:31]
    v_mfma_f32_32x32x16_bf16 v[48:63], a[20:23], v[176:179], v[48:63]
    buffer_load_dwordx4 v[104:107], v1, s[40:43], s70 offen offset:1024 sc1
    s_waitcnt vmcnt(14)
    v_mfma_f32_32x32x16_bf16 v[32:47], a[16:19], v[180:183], v[32:47]
    v_mfma_f32_32x32x16_bf16 v[64:79], a[20:23], v[180:183], v[64:79]
    buffer_load_dwordx4 v[108:111], v1, s[40:43], s78 offen offset:1024 sc1
    s_waitcnt vmcnt(14)
    v_mfma_f32_32x32x16_bf16 v[16:31], a[24:27], v[184:187], v[16:31]
    v_mfma_f32_32x32x16_bf16 v[48:63], a[28:31], v[184:187], v[48:63]
    buffer_load_dwordx4 v[112:115], v1, s[40:43], s72 offen offset:0 sc1
    s_waitcnt vmcnt(14)
    v_mfma_f32_32x32x16_bf16 v[32:47], a[24:27], v[188:191], v[32:47]
    v_mfma_f32_32x32x16_bf16 v[64:79], a[28:31], v[188:191], v[64:79]
    s_waitcnt vmcnt(13)
    s_mov_b32 s11, s27
    s_lshl_b32 s11, s11, 10
    s_add_u32 s11, s11, 23472640
    s_mov_b64 exec, 0xffff
    buffer_store_dwordx4 v[250:253], v1, s[40:43], s11 offen sc1
    s_mov_b64 exec, -1
    buffer_load_dwordx4 v[116:119], v1, s[40:43], s80 offen offset:0 sc1
    s_waitcnt vmcnt(14)
    v_mfma_f32_32x32x16_bf16 v[16:31], a[32:35], v[192:195], v[16:31]
    v_mfma_f32_32x32x16_bf16 v[48:63], a[36:39], v[192:195], v[48:63]
    buffer_load_dwordx4 v[120:123], v1, s[40:43], s73 offen offset:3072 sc1
    s_waitcnt vmcnt(14)
    v_mfma_f32_32x32x16_bf16 v[32:47], a[32:35], v[196:199], v[32:47]
    v_mfma_f32_32x32x16_bf16 v[64:79], a[36:39], v[196:199], v[64:79]
    buffer_load_dwordx4 v[124:127], v1, s[40:43], s81 offen offset:3072 sc1
    s_waitcnt vmcnt(14)
    v_mfma_f32_32x32x16_bf16 v[16:31], a[40:43], v[200:203], v[16:31]
    v_mfma_f32_32x32x16_bf16 v[48:63], a[44:47], v[200:203], v[48:63]
    s_waitcnt vmcnt(13)
    v_mfma_f32_32x32x16_bf16 v[32:47], a[40:43], v[204:207], v[32:47]
    v_mfma_f32_32x32x16_bf16 v[64:79], a[44:47], v[204:207], v[64:79]
    s_waitcnt vmcnt(12)
    v_mfma_f32_32x32x16_bf16 v[16:31], a[48:51], v[80:83], v[16:31]
    v_mfma_f32_32x32x16_bf16 v[48:63], a[52:55], v[80:83], v[48:63]
    s_mov_b64 s[14:15], s[34:35]
    s_mov_b32 s13, 3
L_poll_43:
    s_waitcnt lgkmcnt(0)
    s_xor_b64 s[52:53], s[52:53], s[50:51]
    s_xor_b64 s[54:55], s[54:55], s[50:51]
    s_or_b64 s[52:53], s[52:53], s[54:55]
    s_xor_b64 s[56:57], s[56:57], s[50:51]
    s_or_b64 s[52:53], s[52:53], s[56:57]
    s_xor_b64 s[58:59], s[58:59], s[50:51]
    s_or_b64 s[52:53], s[52:53], s[58:59]
    s_cbranch_scc0 L_pdone_44
    s_sub_u32 s13, s13, 1
    s_cbranch_scc1 L_pslow_45
    s_sleep 4
    s_add_u32 s14, s14, 64
    s_addc_u32 s15, s15, 0
    s_load_dword s52, s[14:15], s20 offset:256
    s_load_dword s53, s[14:15], s20 offset:1280
    s_load_dword s54, s[14:15], s20 offset:2304
    s_load_dword s55, s[14:15], s20 offset:3328
    s_load_dword s56, s[14:15], s20 offset:16640
    s_load_dword s57, s[14:15], s20 offset:17664
    s_load_dword s58, s[14:15], s20 offset:18688
    s_load_dword s59, s[14:15], s20 offset:19712
    s_branch L_poll_43
L_pdone_44:
    buffer_load_dwordx4 v[128:131], v1, s[40:43], s68 offen offset:3072 sc1
    buffer_load_dwordx4 v[132:135], v1, s[40:43], s76 offen offset:3072 sc1
    buffer_load_dwordx4 v[136:139], v1, s[40:43], s70 offen offset:2048 sc1
    s_waitcnt vmcnt(14)
    v_mfma_f32_32x32x16_bf16 v[32:47], a[48:51], v[84:87], v[32:47]
    v_mfma_f32_32x32x16_bf16 v[64:79], a[52:55], v[84:87], v[64:79]
    buffer_load_dwordx4 v[140:143], v1, s[40:43], s78 offen offset:2048 sc1
    s_waitcnt vmcnt(14)
    v_mfma_f32_32x32x16_bf16 v[16:31], a[56:59], v[88:91], v[16:31]
    v_mfma_f32_32x32x16_bf16 v[48:63], a[60:63], v[88:91], v[48:63]
    buffer_load_dwordx4 v[144:147], v1, s[40:43], s72 offen offset:1024 sc1
    s_waitcnt vmcnt(14)
    v_mfma_f32_32x32x16_bf16 v[32:47], a[56:59], v[92:95], v[32:47]
    v_mfma_f32_32x32x16_bf16 v[64:79], a[60:63], v[92:95], v[64:79]
    buffer_load_dwordx4 v[148:151], v1, s[40:43], s80 offen offset:1024 sc1
    s_waitcnt vmcnt(14)
    v_mfma_f32_32x32x16_bf16 v[16:31], a[64:67], v[96:99], v[16:31]
    v_mfma_f32_32x32x16_bf16 v[48:63], a[68:71], v[96:99], v[48:63]
    buffer_load_dwordx4 v[152:155], v1, s[40:43], s74 offen offset:0 sc1
    s_waitcnt vmcnt(14)
    v_mfma_f32_32x32x16_bf16 v[32:47], a[64:67], v[100:103], v[32:47]
    v_mfma_f32_32x32x16_bf16 v[64:79], a[68:71], v[100:103], v[64:79]
    buffer_load_dwordx4 v[156:159], v1, s[40:43], s82 offen offset:0 sc1
    s_waitcnt vmcnt(14)
    v_mfma_f32_32x32x16_bf16 v[16:31], a[72:75], v[104:107], v[16:31]
    v_mfma_f32_32x32x16_bf16 v[48:63], a[76:79], v[104:107], v[48:63]
    buffer_load_dwordx4 v[160:163], v1, s[40:43], s69 offen offset:0 sc1
    s_waitcnt vmcnt(14)
    v_mfma_f32_32x32x16_bf16 v[32:47], a[72:75], v[108:111], v[32:47]
    v_mfma_f32_32x32x16_bf16 v[64:79], a[76:79], v[108:111], v[64:79]
    buffer_load_dwordx4 v[164:167], v1, s[40:43], s77 offen offset:0 sc1
    s_waitcnt vmcnt(14)
    v_mfma_f32_32x32x16_bf16 v[16:31], a[80:83], v[112:115], v[16:31]
    v_mfma_f32_32x32x16_bf16 v[48:63], a[84:87], v[112:115], v[48:63]
    v_and_b32 v4, 31, v0
    v_mul_u32_u24 v4, 896, v4
    v_lshrrev_b32 v2, 5, v0
    buffer_load_dwordx4 v[168:171], v1, s[40:43], s70 offen offset:3072 sc1
    s_waitcnt vmcnt(13)
    v_mfma_f32_32x32x16_bf16 v[32:47], a[80:83], v[116:119], v[32:47]
    v_mfma_f32_32x32x16_bf16 v[64:79], a[84:87], v[116:119], v[64:79]
    v_lshl_add_u32 v4, v2, 4, v4
    s_lshl_b32 s18, s6, 1
    s_and_b32 s12, s3, 1
    buffer_load_dwordx4 v[172:175], v1, s[40:43], s78 offen offset:3072 sc1
    s_waitcnt vmcnt(13)
    v_mfma_f32_32x32x16_bf16 v[16:31], a[88:91], v[120:123], v[16:31]
    v_mfma_f32_32x32x16_bf16 v[48:63], a[92:95], v[120:123], v[48:63]
    s_add_u32 s18, s18, s12
    s_mul_i32 s18, s18, 28672
    s_lshl_b32 s12, s7, 7
    buffer_load_dwordx4 v[176:179], v1, s[40:43], s72 offen offset:2048 sc1
    s_waitcnt vmcnt(13)
    v_mfma_f32_32x32x16_bf16 v[32:47], a[88:91], v[124:127], v[32:47]
    v_mfma_f32_32x32x16_bf16 v[64:79], a[92:95], v[124:127], v[64:79]
    s_add_u32 s18, s18, s12
    s_lshr_b32 s12, s3, 1
    s_lshl_b32 s12, s12, 6
    buffer_load_dwordx4 v[180:183], v1, s[40:43], s80 offen offset:2048 sc1
    s_load_dword s52, s[34:35], s20 offset:512
    s_load_dword s53, s[34:35], s20 offset:1536
    s_load_dword s54, s[34:35], s20 offset:2560
    s_load_dword s55, s[34:35], s20 offset:3584
    s_load_dword s56, s[34:35], s20 offset:16896
    s_load_dword s57, s[34:35], s20 offset:17920
    s_load_dword s58, s[34:35], s20 offset:18944
    s_load_dword s59, s[34:35], s20 offset:19968
    s_waitcnt vmcnt(13)
    v_mfma_f32_32x32x16_bf16 v[16:31], a[96:99], v[128:131], v[16:31]
    v_mfma_f32_32x32x16_bf16 v[48:63], a[100:103], v[128:131], v[48:63]
    s_add_u32 s18, s18, s12
    s_xor_b32 s12, s3, 0
    s_mul_i32 s12, s12, 12288
    buffer_load_dwordx4 v[184:187], v1, s[40:43], s74 offen offset:1024 sc1
    s_waitcnt vmcnt(13)
    v_mfma_f32_32x32x16_bf16 v[32:47], a[96:99], v[132:135], v[32:47]
    v_mfma_f32_32x32x16_bf16 v[64:79], a[100:103], v[132:135], v[64:79]
    s_add_u32 s12, s12, 57344
    v_add_u32 v12, s12, v1
    s_xor_b32 s12, s3, 1
    buffer_load_dwordx4 v[188:191], v1, s[40:43], s82 offen offset:1024 sc1
    s_waitcnt vmcnt(13)
    v_mfma_f32_32x32x16_bf16 v[16:31], a[104:107], v[136:139], v[16:31]
    v_mfma_f32_32x32x16_bf16 v[48:63], a[108:111], v[136:139], v[48:63]
    s_mul_i32 s12, s12, 12288
    s_add_u32 s12, s12, 57344
    v_add_u32 v13, s12, v1
    buffer_load_dwordx4 v[192:195], v1, s[40:43], s77 offen offset:1024 sc1
    s_waitcnt vmcnt(13)
    v_mfma_f32_32x32x16_bf16 v[32:47], a[104:107], v[140:143], v[32:47]
    v_mfma_f32_32x32x16_bf16 v[64:79], a[108:111], v[140:143], v[64:79]
    s_xor_b32 s12, s3, 2
    s_mul_i32 s12, s12, 12288
    s_add_u32 s12, s12, 57344
    buffer_load_dwordx4 v[196:199], v1, s[40:43], s79 offen offset:0 sc1
    s_waitcnt vmcnt(13)
    v_mfma_f32_32x32x16_bf16 v[16:31], a[112:115], v[144:147], v[16:31]
    v_mfma_f32_32x32x16_bf16 v[48:63], a[116:119], v[144:147], v[48:63]
    v_add_u32 v14, s12, v1
    s_xor_b32 s12, s3, 3
    s_mul_i32 s12, s12, 12288
    buffer_load_dwordx4 v[200:203], v1, s[40:43], s80 offen offset:3072 sc1
    s_waitcnt vmcnt(13)
    v_mfma_f32_32x32x16_bf16 v[32:47], a[112:115], v[148:151], v[32:47]
    v_mfma_f32_32x32x16_bf16 v[64:79], a[116:119], v[148:151], v[64:79]
    s_add_u32 s12, s12, 57344
    v_add_u32 v15, s12, v1
    buffer_load_dwordx4 v[204:207], v1, s[40:43], s82 offen offset:2048 sc1
    s_waitcnt vmcnt(13)
    v_mfma_f32_32x32x16_bf16 v[16:31], a[120:123], v[152:155], v[16:31]
    v_mfma_f32_32x32x16_bf16 v[48:63], a[124:127], v[152:155], v[48:63]
    s_waitcnt vmcnt(12)
    v_mfma_f32_32x32x16_bf16 v[32:47], a[120:123], v[156:159], v[32:47]
    v_mfma_f32_32x32x16_bf16 v[64:79], a[124:127], v[156:159], v[64:79]
    s_waitcnt vmcnt(11)
    v_mfma_f32_32x32x16_bf16 v[16:31], a[128:131], v[160:163], v[16:31]
    v_mfma_f32_32x32x16_bf16 v[48:63], a[132:135], v[160:163], v[48:63]
    s_mov_b64 s[14:15], s[34:35]
    s_mov_b32 s13, 3
L_poll_46:
    s_waitcnt lgkmcnt(0)
    s_xor_b64 s[52:53], s[52:53], s[50:51]
    s_xor_b64 s[54:55], s[54:55], s[50:51]
    s_or_b64 s[52:53], s[52:53], s[54:55]
    s_xor_b64 s[56:57], s[56:57], s[50:51]
    s_or_b64 s[52:53], s[52:53], s[56:57]
    s_xor_b64 s[58:59], s[58:59], s[50:51]
    s_or_b64 s[52:53], s[52:53], s[58:59]
    s_cbranch_scc0 L_pdone_47
    s_sub_u32 s13, s13, 1
    s_cbranch_scc1 L_pslow_48
    s_sleep 4
    s_add_u32 s14, s14, 64
    s_addc_u32 s15, s15, 0
    s_load_dword s52, s[14:15], s20 offset:512
    s_load_dword s53, s[14:15], s20 offset:1536
    s_load_dword s54, s[14:15], s20 offset:2560
    s_load_dword s55, s[14:15], s20 offset:3584
    s_load_dword s56, s[14:15], s20 offset:16896
    s_load_dword s57, s[14:15], s20 offset:17920
    s_load_dword s58, s[14:15], s20 offset:18944
    s_load_dword s59, s[14:15], s20 offset:19968
    s_branch L_poll_46
L_pdone_47:
    buffer_load_dwordx4 v[80:83], v1, s[40:43], s77 offen offset:2048 sc1
    buffer_load_dwordx4 v[84:87], v1, s[40:43], s79 offen offset:1024 sc1
    buffer_load_dwordx4 v[88:91], v1, s[40:43], s81 offen offset:0 sc1
    s_waitcnt vmcnt(13)
    v_mfma_f32_32x32x16_bf16 v[32:47], a[128:131], v[164:167], v[32:47]
    v_mfma_f32_32x32x16_bf16 v[64:79], a[132:135], v[164:167], v[64:79]
    buffer_load_dwordx4 v[92:95], v1, s[40:43], s82 offen offset:3072 sc1
    s_waitcnt vmcnt(13)
    v_mfma_f32_32x32x16_bf16 v[16:31], a[136:139], v[168:171], v[16:31]
    v_mfma_f32_32x32x16_bf16 v[48:63], a[140:143], v[168:171], v[48:63]
    buffer_load_dwordx4 v[96:99], v1, s[40:43], s69 offen offset:1024 sc1
    s_waitcnt vmcnt(13)
    v_mfma_f32_32x32x16_bf16 v[32:47], a[136:139], v[172:175], v[32:47]
    v_mfma_f32_32x32x16_bf16 v[64:79], a[140:143], v[172:175], v[64:79]
    buffer_load_dwordx4 v[100:103], v1, s[40:43], s71 offen offset:0 sc1
    s_waitcnt vmcnt(13)
    v_mfma_f32_32x32x16_bf16 v[16:31], a[144:147], v[176:179], v[16:31]
    v_mfma_f32_32x32x16_bf16 v[48:63], a[148:151], v[176:179], v[48:63]
    buffer_load_dwordx4 v[104:107], v1, s[40:43], s72 offen offset:3072 sc1
    s_waitcnt vmcnt(13)
    v_mfma_f32_32x32x16_bf16 v[32:47], a[144:147], v[180:183], v[32:47]
    v_mfma_f32_32x32x16_bf16 v[64:79], a[148:151], v[180:183], v[64:79]
    buffer_load_dwordx4 v[108:111], v1, s[40:43], s74 offen offset:2048 sc1
    s_waitcnt vmcnt(13)
    v_mfma_f32_32x32x16_bf16 v[16:31], a[152:155], v[184:187], v[16:31]
    v_mfma_f32_32x32x16_bf16 v[48:63], a[156:159], v[184:187], v[48:63]
    buffer_load_dwordx4 v[112:115], v1, s[40:43], s69 offen offset:2048 sc1
    s_waitcnt vmcnt(13)
    v_mfma_f32_32x32x16_bf16 v[32:47], a[152:155], v[188:191], v[32:47]
    v_mfma_f32_32x32x16_bf16 v[64:79], a[156:159], v[188:191], v[64:79]
    buffer_load_dwordx4 v[116:119], v1, s[40:43], s71 offen offset:1024 sc1
    s_waitcnt vmcnt(13)
    v_mfma_f32_32x32x16_bf16 v[32:47], a[160:163], v[192:195], v[32:47]
    v_mfma_f32_32x32x16_bf16 v[64:79], a[164:167], v[192:195], v[64:79]
    buffer_load_dwordx4 v[120:123], v1, s[40:43], s73 offen offset:0 sc1
    s_waitcnt vmcnt(13)
    v_mfma_f32_32x32x16_bf16 v[32:47], a[168:171], v[196:199], v[32:47]
    v_mfma_f32_32x32x16_bf16 v[64:79], a[172:175], v[196:199], v[64:79]
    buffer_load_dwordx4 v[124:127], v1, s[40:43], s74 offen offset:3072 sc1
    s_waitcnt vmcnt(13)
    v_mfma_f32_32x32x16_bf16 v[32:47], a[176:179], v[200:203], v[32:47]
    v_mfma_f32_32x32x16_bf16 v[64:79], a[180:183], v[200:203], v[64:79]
    s_waitcnt vmcnt(12)
    v_mfma_f32_32x32x16_bf16 v[32:47], a[184:187], v[204:207], v[32:47]
    v_mfma_f32_32x32x16_bf16 v[64:79], a[188:191], v[204:207], v[64:79]
    s_waitcnt vmcnt(11)
    v_mfma_f32_32x32x16_bf16 v[32:47], a[192:195], v[80:83], v[32:47]
    v_mfma_f32_32x32x16_bf16 v[64:79], a[196:199], v[80:83], v[64:79]
    s_waitcnt vmcnt(10)
    v_mfma_f32_32x32x16_bf16 v[32:47], a[200:203], v[84:87], v[32:47]
    v_mfma_f32_32x32x16_bf16 v[64:79], a[204:207], v[84:87], v[64:79]
    s_waitcnt vmcnt(9)
    v_mfma_f32_32x32x16_bf16 v[32:47], a[208:211], v[88:91], v[32:47]
    v_mfma_f32_32x32x16_bf16 v[64:79], a[212:215], v[88:91], v[64:79]
    s_waitcnt vmcnt(8)
    v_mfma_f32_32x32x16_bf16 v[32:47], a[216:219], v[92:95], v[32:47]
    v_mfma_f32_32x32x16_bf16 v[64:79], a[220:223], v[92:95], v[64:79]
    s_waitcnt vmcnt(7)
    v_mfma_f32_32x32x16_bf16 v[16:31], a[160:163], v[96:99], v[16:31]
    v_mfma_f32_32x32x16_bf16 v[48:63], a[164:167], v[96:99], v[48:63]
    s_waitcnt vmcnt(6)
    v_mfma_f32_32x32x16_bf16 v[16:31], a[168:171], v[100:103], v[16:31]
    v_mfma_f32_32x32x16_bf16 v[48:63], a[172:175], v[100:103], v[48:63]
    s_nop 4
    ds_write_b128 v13, v[32:35] offset:0
    s_waitcnt vmcnt(5)
    v_mfma_f32_32x32x16_bf16 v[16:31], a[176:179], v[104:107], v[16:31]
    ds_write_b128 v13, v[36:39] offset:1024
    v_mfma_f32_32x32x16_bf16 v[48:63], a[180:183], v[104:107], v[48:63]
    ds_write_b128 v13, v[40:43] offset:2048
    s_waitcnt vmcnt(4)
    v_mfma_f32_32x32x16_bf16 v[16:31], a[184:187], v[108:111], v[16:31]
    ds_write_b128 v13, v[44:47] offset:3072
    v_mfma_f32_32x32x16_bf16 v[48:63], a[188:191], v[108:111], v[48:63]
    ds_write_b128 v15, v[64:67] offset:8192
    s_waitcnt vmcnt(3)
    v_mfma_f32_32x32x16_bf16 v[16:31], a[192:195], v[112:115], v[16:31]
    ds_write_b128 v15, v[68:71] offset:9216
    v_mfma_f32_32x32x16_bf16 v[48:63], a[196:199], v[112:115], v[48:63]
    ds_write_b128 v15, v[72:75] offset:10240
    s_waitcnt vmcnt(2)
    v_mfma_f32_32x32x16_bf16 v[16:31], a[200:203], v[116:119], v[16:31]
    ds_write_b128 v15, v[76:79] offset:11264
    v_mfma_f32_32x32x16_bf16 v[48:63], a[204:207], v[116:119], v[48:63]
    s_waitcnt vmcnt(1)
    v_mfma_f32_32x32x16_bf16 v[16:31], a[208:211], v[120:123], v[16:31]
    v_mfma_f32_32x32x16_bf16 v[48:63], a[212:215], v[120:123], v[48:63]
    s_waitcnt vmcnt(0)
    v_mfma_f32_32x32x16_bf16 v[48:63], a[220:223], v[124:127], v[48:63]
    v_mfma_f32_32x32x16_bf16 v[16:31], a[216:219], v[124:127], v[16:31]
    s_nop 10
    ds_write_b128 v14, v[48:51] offset:4096
    ds_write_b128 v14, v[52:55] offset:5120
    ds_write_b128 v14, v[56:59] offset:6144
    ds_write_b128 v14, v[60:63] offset:7168
    s_waitcnt lgkmcnt(0)
    s_barrier
    ds_read_b128 v[80:83], v12 offset:0
    ds_read_b128 v[84:87], v12 offset:1024
    ds_read_b128 v[88:91], v12 offset:2048
    ds_read_b128 v[92:95], v12 offset:3072
    ds_read_b128 v[96:99], v12 offset:4096
    ds_read_b128 v[100:103], v12 offset:5120
    ds_read_b128 v[104:107], v12 offset:6144
    ds_read_b128 v[108:111], v12 offset:7168
    ds_read_b128 v[112:115], v12 offset:8192
    ds_read_b128 v[116:119], v12 offset:9216
    ds_read_b128 v[120:123], v12 offset:10240
    ds_read_b128 v[124:127], v12 offset:11264
    s_waitcnt lgkmcnt(11)
    v_pk_add_f32 v[16:17], v[16:17], v[80:81]
    v_pk_add_f32 v[18:19], v[18:19], v[82:83]
    s_waitcnt lgkmcnt(10)
    v_pk_add_f32 v[20:21], v[20:21], v[84:85]
    v_pk_add_f32 v[22:23], v[22:23], v[86:87]
    s_waitcnt lgkmcnt(9)
    v_pk_add_f32 v[24:25], v[24:25], v[88:89]
    v_pk_add_f32 v[26:27], v[26:27], v[90:91]
    s_waitcnt lgkmcnt(8)
    v_pk_add_f32 v[28:29], v[28:29], v[92:93]
    v_pk_add_f32 v[30:31], v[30:31], v[94:95]
    s_waitcnt lgkmcnt(7)
    v_pk_add_f32 v[16:17], v[16:17], v[96:97]
    v_pk_add_f32 v[18:19], v[18:19], v[98:99]
    s_waitcnt lgkmcnt(6)
    v_pk_add_f32 v[20:21], v[20:21], v[100:101]
    v_pk_add_f32 v[22:23], v[22:23], v[102:103]
    s_waitcnt lgkmcnt(5)
    v_pk_add_f32 v[24:25], v[24:25], v[104:105]
    v_pk_add_f32 v[26:27], v[26:27], v[106:107]
    s_waitcnt lgkmcnt(4)
    v_pk_add_f32 v[28:29], v[28:29], v[108:109]
    v_pk_add_f32 v[30:31], v[30:31], v[110:111]
    s_waitcnt lgkmcnt(3)
    v_pk_add_f32 v[16:17], v[16:17], v[112:113]
    v_pk_add_f32 v[18:19], v[18:19], v[114:115]
    s_waitcnt lgkmcnt(2)
    v_pk_add_f32 v[20:21], v[20:21], v[116:117]
    v_pk_add_f32 v[22:23], v[22:23], v[118:119]
    s_waitcnt lgkmcnt(1)
    v_pk_add_f32 v[24:25], v[24:25], v[120:121]
    v_pk_add_f32 v[26:27], v[26:27], v[122:123]
    s_waitcnt lgkmcnt(0)
    v_pk_add_f32 v[28:29], v[28:29], v[124:125]
    v_pk_add_f32 v[30:31], v[30:31], v[126:127]
    v_cvt_pk_bf16_f32 v128, v16, v17
    v_cvt_pk_bf16_f32 v129, v18, v19
    v_cvt_pk_bf16_f32 v130, v20, v21
    v_cvt_pk_bf16_f32 v131, v22, v23
    buffer_store_dwordx4 v[128:131], v4, s[44:47], s18 offen offset:0
    v_cvt_pk_bf16_f32 v132, v24, v25
    v_cvt_pk_bf16_f32 v133, v26, v27
    v_cvt_pk_bf16_f32 v134, v28, v29
    v_cvt_pk_bf16_f32 v135, v30, v31
    buffer_store_dwordx4 v[132:135], v4, s[44:47], s18 offen offset:32
L_exit:
    s_endpgm
L_idle5:
    s_nop 15
    s_waitcnt lgkmcnt(0)
    v_pk_mul_f32 v[224:225], v[144:145], v[144:145]
    v_pk_mul_f32 v[226:227], v[146:147], v[146:147]
    v_pk_mul_f32 v[228:229], v[148:149], v[148:149]
    v_pk_mul_f32 v[230:231], v[150:151], v[150:151]
    v_pk_fma_f32 v[224:225], v[224:225], v[10:11], v[8:9] op_sel:[0,0,1] op_sel_hi:[1,0,1]
    v_pk_fma_f32 v[226:227], v[226:227], v[10:11], v[8:9] op_sel:[0,0,1] op_sel_hi:[1,0,1]
    v_pk_fma_f32 v[228:229], v[228:229], v[10:11], v[8:9] op_sel:[0,0,1] op_sel_hi:[1,0,1]
    v_pk_fma_f32 v[230:231], v[230:231], v[10:11], v[8:9] op_sel:[0,0,1] op_sel_hi:[1,0,1]
    v_pk_mul_f32 v[152:153], v[144:145], v[152:153]
    v_pk_mul_f32 v[154:155], v[146:147], v[154:155]
    v_pk_mul_f32 v[156:157], v[148:149], v[156:157]
    v_pk_mul_f32 v[158:159], v[150:151], v[158:159]
    v_pk_mul_f32 v[144:145], v[224:225], v[144:145]
    v_pk_mul_f32 v[146:147], v[226:227], v[146:147]
    v_pk_mul_f32 v[148:149], v[228:229], v[148:149]
    v_pk_mul_f32 v[150:151], v[230:231], v[150:151]
    v_exp_f32 v144, v144
    v_exp_f32 v145, v145
    v_exp_f32 v146, v146
    v_exp_f32 v147, v147
    v_exp_f32 v148, v148
    v_exp_f32 v149, v149
    v_exp_f32 v150, v150
    v_exp_f32 v151, v151
    v_pk_fma_f32 v[144:145], v[144:145], v[10:11], v[10:11] op_sel:[0,1,1] op_sel_hi:[1,1,1]
    v_pk_fma_f32 v[146:147], v[146:147], v[10:11], v[10:11] op_sel:[0,1,1] op_sel_hi:[1,1,1]
    v_pk_fma_f32 v[148:149], v[148:149], v[10:11], v[10:11] op_sel:[0,1,1] op_sel_hi:[1,1,1]
    v_pk_fma_f32 v[150:151], v[150:151], v[10:11], v[10:11] op_sel:[0,1,1] op_sel_hi:[1,1,1]
    v_rcp_f32 v144, v144
    v_rcp_f32 v145, v145
    v_rcp_f32 v146, v146
    v_rcp_f32 v147, v147
    v_rcp_f32 v148, v148
    v_rcp_f32 v149, v149
    v_rcp_f32 v150, v150
    v_rcp_f32 v151, v151
    v_pk_mul_f32 v[144:145], v[144:145], v[152:153]
    v_pk_mul_f32 v[146:147], v[146:147], v[154:155]
    v_pk_mul_f32 v[148:149], v[148:149], v[156:157]
    v_pk_mul_f32 v[150:151], v[150:151], v[158:159]
    v_cvt_pk_bf16_f32 v232, v144, v145
    v_cvt_pk_bf16_f32 v233, v146, v147
    v_cvt_pk_bf16_f32 v234, v148, v149
    v_cvt_pk_bf16_f32 v235, v150, v151
    buffer_store_dwordx4 v[232:235], v1, s[40:43], s28 offen offset:2048 sc1
    s_waitcnt vmcnt(0)
    s_mov_b32 s11, s27
    s_lshl_b32 s11, s11, 10
    s_add_u32 s11, s11, 23472640
    s_mov_b64 exec, 0xffff
    buffer_store_dwordx4 v[250:253], v1, s[40:43], s11 offen sc1
    s_mov_b64 exec, -1
    s_lshl_b32 s11, s2, 2
    s_add_u32 s11, s11, s3
    s_cmp_lg_u32 s11, 1020
    s_cbranch_scc1 L_noclr
    v_lshlrev_b32 v2, 8, v0
    s_mov_b32 s11, 24782848
    buffer_load_dword v4, v2, s[40:43], s11 offen sc1
    s_mov_b32 s11, 24799232
    buffer_load_dword v5, v2, s[40:43], s11 offen sc1
    s_mov_b32 s11, 24815616
    buffer_load_dword v6, v2, s[40:43], s11 offen sc1
    s_mov_b32 s11, 24832000
    buffer_load_dword v7, v2, s[40:43], s11 offen sc1
    s_waitcnt vmcnt(3)
    v_xor_b32 v4, s50, v4
    s_waitcnt vmcnt(2)
    v_xor_b32 v5, s50, v5
    s_waitcnt vmcnt(1)
    v_xor_b32 v6, s50, v6
    s_waitcnt vmcnt(0)
    v_xor_b32 v7, s50, v7
    v_or3_b32 v4, v4, v5, v6
    v_or_b32 v4, v4, v7
    v_cmp_ne_u32 vcc, 0, v4
    s_nop 4
    s_cbranch_vccnz L_noclr
    v_mov_b32 v2, 0
    s_mov_b64 exec, 1
    global_store_dword v2, v2, s[32:33] sc1
    s_mov_b64 exec, -1
L_noclr:
    s_endpgm
L_idle3:
    s_waitcnt vmcnt(0)
L_pw_49:
    buffer_load_dword v255, off, s[40:43], s20 offset:192 sc1
    s_waitcnt vmcnt(0)
    v_cmp_ne_u32 vcc, s50, v255
    s_nop 4
    s_cbranch_vccz L_pwd_50
    s_sub_u32 s10, s10, 1
    s_cbranch_scc1 L_exit
    s_sleep 8
    s_branch L_pw_49
L_pwd_50:
    s_load_dword s52, s[34:35], s23 offset:0
    s_load_dword s53, s[34:35], s23 offset:256
    s_load_dword s54, s[34:35], s23 offset:512
    s_load_dword s55, s[34:35], s23 offset:1792
    s_load_dword s56, s[34:35], s23 offset:2048
    s_load_dword s57, s[34:35], s23 offset:2304
    s_load_dword s58, s[34:35], s23 offset:3584
    s_load_dword s59, s[34:35], s23 offset:3840
    s_load_dword s60, s[34:35], s23 offset:4096
    s_load_dword s61, s[34:35], s23 offset:4096
    s_mov_b64 s[14:15], s[34:35]
    s_mov_b32 s13, 3
L_poll_51:
    s_waitcnt lgkmcnt(0)
    s_xor_b64 s[52:53], s[52:53], s[50:51]
    s_xor_b64 s[54:55], s[54:55], s[50:51]
    s_or_b64 s[52:53], s[52:53], s[54:55]
    s_xor_b64 s[56:57], s[56:57], s[50:51]
    s_or_b64 s[52:53], s[52:53], s[56:57]
    s_xor_b64 s[58:59], s[58:59], s[50:51]
    s_or_b64 s[52:53], s[52:53], s[58:59]
    s_xor_b64 s[60:61], s[60:61], s[50:51]
    s_or_b64 s[52:53], s[52:53], s[60:61]
    s_cbranch_scc0 L_pdone_52
    s_sub_u32 s13, s13, 1
    s_cbranch_scc1 L_pslow_53
    s_sleep 4
    s_add_u32 s14, s14, 64
    s_addc_u32 s15, s15, 0
    s_load_dword s52, s[14:15], s23 offset:0
    s_load_dword s53, s[14:15], s23 offset:256
    s_load_dword s54, s[14:15], s23 offset:512
    s_load_dword s55, s[14:15], s23 offset:1792
    s_load_dword s56, s[14:15], s23 offset:2048
    s_load_dword s57, s[14:15], s23 offset:2304
    s_load_dword s58, s[14:15], s23 offset:3584
    s_load_dword s59, s[14:15], s23 offset:3840
    s_load_dword s60, s[14:15], s23 offset:4096
    s_load_dword s61, s[14:15], s23 offset:4096
    s_branch L_poll_51
L_pdone_52:
    s_add_u32 m0, s31, 0
    s_add_u32 s49, s30, 0
    buffer_load_dwordx4 v1, s[40:43], s49 offen offset:0 sc1 lds
    buffer_load_dwordx4 v1, s[40:43], s49 offen offset:1024 sc1 lds
    buffer_load_dwordx4 v1, s[40:43], s49 offen offset:2048 sc1 lds
    buffer_load_dwordx4 v1, s[40:43], s49 offen offset:3072 sc1 lds
    s_add_u32 m0, s31, 4096
    s_add_u32 s49, s30, 4096
    buffer_load_dwordx4 v1, s[40:43], s49 offen offset:0 sc1 lds
    buffer_load_dwordx4 v1, s[40:43], s49 offen offset:1024 sc1 lds
    buffer_load_dwordx4 v1, s[40:43], s49 offen offset:2048 sc1 lds
    s_add_u32 m0, s31, 28672
    s_add_u32 s49, s30, 28672
    buffer_load_dwordx4 v1, s[40:43], s49 offen offset:0 sc1 lds
    s_waitcnt vmcnt(0)
    s_branch L_skip3
L_idle3b:
    s_waitcnt vmcnt(0)
L_pw_54:
    buffer_load_dword v255, off, s[40:43], s20 offset:192 sc1
    s_waitcnt vmcnt(0)
    v_cmp_ne_u32 vcc, s50, v255
    s_nop 4
    s_cbranch_vccz L_pwd_55
    s_sub_u32 s10, s10, 1
    s_cbranch_scc1 L_exit
    s_sleep 8
    s_branch L_pw_54
L_pwd_55:
    s_branch L_go4
L_idle1:
    s_waitcnt lgkmcnt(0)
    s_mov_b32 s36, s16
    s_and_b32 s37, s17, 0xffff
    s_mov_b32 s38, 1835008
    s_mov_b32 s39, 0x20000
    s_mov_b32 s40, s34
    s_and_b32 s41, s35, 0xffff
    s_mov_b32 s42, 29622272
    s_mov_b32 s43, 0x20000
    s_lshl_b32 s13, s2, 2
    s_add_u32 s13, s13, s3
    s_cmp_lg_u32 s13, 1020
    s_cbranch_scc1 L_noep_56
    s_mov_b32 s13, 24856576
    s_load_dword s12, s[34:35], s13 glc
    s_waitcnt lgkmcnt(0)
    s_add_u32 s12, s12, 1
    s_max_u32 s12, s12, 1
    v_mov_b32 v8, s12
    v_mov_b32 v9, 0
    s_mov_b64 exec, 1
    buffer_store_dword v8, off, s[40:43], s13 sc1
    global_store_dword v9, v8, s[32:33] sc1
    s_mov_b64 exec, -1
L_noep_56:
    v_lshrrev_b32 v2, 3, v0
    v_and_b32 v3, 7, v0
    s_mul_i32 s17, s3, 40960
    s_mov_b32 s60, s24
    s_and_b32 s61, s25, 0xffff
    s_mov_b32 s62, 1605632
    s_mov_b32 s63, 0x20000
    s_mov_b32 s64, s26
    s_and_b32 s65, s27, 0xffff
    s_mov_b32 s66, 1605632
    s_mov_b32 s67, 0x20000
    s_mov_b32 s52, s28
    s_and_b32 s53, s29, 0xffff
    s_mov_b32 s54, 1605632
    s_mov_b32 s55, 0x20000
    s_mov_b32 s56, s20
    s_and_b32 s57, s21, 0xffff
    s_mov_b32 s58, 401408
    s_mov_b32 s59, 0x20000
    s_mov_b32 s40, s34
    s_and_b32 s41, s35, 0xffff
    s_mov_b32 s42, 29622272
    s_mov_b32 s43, 0x20000
    s_mov_b32 s44, s30
    s_and_b32 s45, s31, 0xffff
    s_mov_b32 s46, 1835008
    s_mov_b32 s47, 0x20000
    s_and_b32 s11, s5, 1
    s_lshl_b32 s12, s7, 1
    s_add_u32 s12, s12, s11
    s_lshr_b32 s13, s6, 1
    s_lshr_b32 s8, s5, 1
    s_lshl_b32 s9, s4, 1
    s_add_u32 s9, s9, s11
    s_and_b32 s11, s4, 1
    s_lshl_b32 s11, s11, 3
    s_add_u32 s11, s11, s7
    s_lshr_b32 s12, s4, 1
    s_lshl_b32 s12, s12, 2
    s_and_b32 s13, s5, 3
    s_add_u32 s4, s12, s13
    s_mov_b32 s5, s11
    s_lshr_b32 s11, s3, 1
    s_lshl_b32 s11, s11, 10
    v_xor_b32 v248, s11, v1
    v_xor_b32 v249, 1024, v248
    v_lshlrev_b32 v38, 19, v0
    buffer_load_dword v39, v38, s[40:43], 0 offen offset:2048
    buffer_load_dword v39, v38, s[44:47], 0 offen offset:2048
    buffer_load_dword v39, v38, s[60:63], 0 offen
    buffer_load_dword v39, v38, s[64:67], 0 offen
    v_mul_u32_u24 v4, 896, v2
    v_lshl_add_u32 v4, v3, 4, v4
    s_and_b32 s12, s6, 3
    s_mul_i32 s19, s12, 112
    s_lshl_b32 s11, s3, 4
    s_add_u32 s19, s19, s11
    s_lshr_b32 s11, s3, 1
    s_lshl_b32 s11, s11, 3
    s_sub_u32 s19, s19, s11
    s_mul_i32 s19, s19, 896
    s_lshr_b32 s13, s6, 2
    s_lshl_b32 s11, s13, 7
    s_add_u32 s19, s19, s11
    s_lshl_b32 s18, s13, 5
    s_lshl_b32 s11, s12, 3
    s_add_u32 s18, s18, s11
    s_add_u32 s18, s18, s3
    s_lshl_b32 s18, s18, 11
    s_add_u32 s18, s18, 21956608
    s_lshl_b32 s20, s6, 2
    s_add_u32 s20, s20, s3
    s_lshl_b32 s21, s20, 11
    s_add_u32 s21, s21, 20350976
    s_cmp_lt_u32 s6, 28
    s_cselect_b32 s19, s19, 2146435072
    s_cselect_b32 s18, s18, 2146435072
    s_cselect_b32 s21, s21, 2146435072
    s_add_u32 m0, s17, 14336
    s_add_u32 s11, s19, 0
    buffer_load_dwordx4 v4, s[56:59], s11 offen nt lds
    s_add_u32 m0, s17, 15360
    s_add_u32 s11, s19, 7168
    buffer_load_dwordx4 v4, s[56:59], s11 offen nt lds
    s_add_u32 m0, s17, 16384
    s_add_u32 s11, s19, 50176
    buffer_load_dwordx4 v4, s[56:59], s11 offen nt lds
    s_add_u32 m0, s17, 17408
    s_add_u32 s11, s19, 57344
    buffer_load_dwordx4 v4, s[56:59], s11 offen nt lds
    v_lshrrev_b32 v2, 5, v0
    v_lshlrev_b32 v2, 3, v2
    v_bfe_u32 v3, v0, 2, 2
    v_add_u32 v2, v2, v3
    v_mul_u32_u24 v6, 128, v2
    v_bfe_u32 v2, v0, 4, 1
    v_mul_u32_u24 v2, 32, v2
    v_add_u32 v6, v6, v2
    v_and_b32 v2, 1, v0
    v_lshl_add_u32 v6, v2, 4, v6
    v_bfe_u32 v2, v0, 1, 1
    v_lshl_add_u32 v6, v2, 3, v6
    v_add_u32 v6, s17, v6
    v_lshrrev_b32 v2, 5, v0
    v_lshlrev_b32 v2, 3, v2
    v_bfe_u32 v3, v0, 2, 2
    v_add_u32 v2, v2, v3
    v_mul_u32_u24 v7, 896, v2
    v_bfe_u32 v2, v0, 4, 1
    v_mul_u32_u24 v2, 32, v2
    v_add_u32 v7, v7, v2
    v_and_b32 v2, 1, v0
    v_lshl_add_u32 v7, v2, 4, v7
    v_bfe_u32 v2, v0, 1, 1
    v_lshl_add_u32 v7, v2, 3, v7
    v_add_u32 v7, s17, v7
    s_waitcnt vmcnt(0)
    ds_read_b64_tr_b16 v[24:25], v6 offset:14336
    ds_read_b64_tr_b16 v[26:27], v6 offset:14848
    ds_read_b64_tr_b16 v[28:29], v6 offset:14400
    ds_read_b64_tr_b16 v[30:31], v6 offset:14912
    ds_read_b64_tr_b16 v[32:33], v6 offset:16384
    ds_read_b64_tr_b16 v[34:35], v6 offset:16896
    ds_read_b64_tr_b16 v[36:37], v6 offset:16448
    ds_read_b64_tr_b16 v[38:39], v6 offset:16960
    s_add_u32 s19, s18, 8192
    s_waitcnt lgkmcnt(6)
    buffer_store_dwordx4 v[24:27], v1, s[40:43], s18 offen offset:0 sc1
    s_waitcnt lgkmcnt(4)
    buffer_store_dwordx4 v[28:31], v1, s[40:43], s18 offen offset:1024 sc1
    s_waitcnt lgkmcnt(2)
    buffer_store_dwordx4 v[32:35], v1, s[40:43], s19 offen offset:0 sc1
    s_waitcnt lgkmcnt(0)
    buffer_store_dwordx4 v[36:39], v1, s[40:43], s19 offen offset:1024 sc1
    s_mul_i32 s22, s20, 14336
    s_add_u32 m0, s17, 18432
    s_nop 0
    buffer_load_dwordx4 v1, s[52:55], s22 offen offset:0 nt lds
    buffer_load_dwordx4 v1, s[52:55], s22 offen offset:1024 nt lds
    buffer_load_dwordx4 v1, s[52:55], s22 offen offset:2048 nt lds
    buffer_load_dwordx4 v1, s[52:55], s22 offen offset:3072 nt lds
    s_add_u32 m0, s17, 22528
    s_add_u32 s22, s22, 4096
    buffer_load_dwordx4 v1, s[52:55], s22 offen offset:0 nt lds
    buffer_load_dwordx4 v1, s[52:55], s22 offen offset:1024 nt lds
    buffer_load_dwordx4 v1, s[52:55], s22 offen offset:2048 nt lds
    buffer_load_dwordx4 v1, s[52:55], s22 offen offset:3072 nt lds
    s_add_u32 m0, s17, 26624
    s_add_u32 s22, s22, 4096
    buffer_load_dwordx4 v1, s[52:55], s22 offen offset:0 nt lds
    buffer_load_dwordx4 v1, s[52:55], s22 offen offset:1024 nt lds
    buffer_load_dwordx4 v1, s[52:55], s22 offen offset:2048 nt lds
    buffer_load_dwordx4 v1, s[52:55], s22 offen offset:3072 nt lds
    s_add_u32 m0, s17, 30720
    s_add_u32 s22, s22, 4096
    buffer_load_dwordx4 v1, s[52:55], s22 offen offset:0 nt lds
    buffer_load_dwordx4 v1, s[52:55], s22 offen offset:1024 nt lds
    v_mov_b32 v110, v7
    s_mov_b32 s0, s21
    v_and_b32 v2, 31, v0
    v_lshrrev_b32 v3, 5, v0
    v_lshlrev_b32 v3, 2, v3
    v_sub_u32 v2, v3, v2
    s_mov_b32 s11, 0x03020706
    v_add_u32 v3, -1, v2
    v_add_u32 v8, 0, v2
    v_perm_b32 v224, v3, v8, s11
    v_add_u32 v3, 1, v2
    v_add_u32 v8, 2, v2
    v_perm_b32 v225, v3, v8, s11
    v_add_u32 v3, 7, v2
    v_add_u32 v8, 8, v2
    v_perm_b32 v226, v3, v8, s11
    v_add_u32 v3, 9, v2
    v_add_u32 v8, 10, v2
    v_perm_b32 v227, v3, v8, s11
    v_add_u32 v3, 15, v2
    v_add_u32 v8, 16, v2
    v_perm_b32 v228, v3, v8, s11
    v_add_u32 v3, 17, v2
    v_add_u32 v8, 18, v2
    v_perm_b32 v229, v3, v8, s11
    v_add_u32 v3, 23, v2
    v_add_u32 v8, 24, v2
    v_perm_b32 v230, v3, v8, s11
    v_add_u32 v3, 25, v2
    v_add_u32 v8, 26, v2
    v_perm_b32 v231, v3, v8, s11
    s_bitcmp1_b32 s9, 0
    s_cselect_b32 s12, -1, 0
    s_mov_b32 s13, 0
    v_cndmask_b32 v6, -1, 0, s[12:13]
    s_cselect_b32 s13, 0, -1
    s_mov_b32 s12, 0
    v_cndmask_b32 v7, -1, 0, s[12:13]
    s_cselect_b32 s11, 0, 1544
    s_mul_i32 s12, s3, 12288
    s_add_u32 s11, s11, s12
    s_add_u32 s11, s11, 116736
    v_and_b32 v8, 31, v0
    v_lshlrev_b32 v8, 4, v8
    v_add_u32 v8, s11, v8
    v_lshrrev_b32 v9, 5, v0
    v_lshl_add_u32 v9, v9, 12, v8
    v_mov_b32 v10, 0x3f80
    v_mov_b32 v11, 0
    s_lshl_b32 s11, s3, 12
    s_add_u32 s11, s11, 114688
    v_add_u32 v12, s11, v1
    v_and_b32 v2, 1, v0
    v_bfe_u32 v3, v0, 4, 1
    v_lshrrev_b32 v13, 5, v0
    v_xor_b32 v13, v13, v2
    v_lshlrev_b32 v13, 6, v13
    v_lshl_add_u32 v13, v3, 7, v13
    v_lshl_add_u32 v13, v2, 9, v13
    v_lshl_add_u32 v13, v3, 10, v13
    v_bfe_u32 v2, v0, 2, 2
    v_lshl_add_u32 v13, v2, 4, v13
    v_bfe_u32 v2, v0, 1, 1
    v_lshl_add_u32 v13, v2, 3, v13
    v_xor_b32 v14, 128, v13
    s_add_u32 s11, s11, 2048
    v_add_u32 v13, s11, v13
    v_add_u32 v14, s11, v14
    v_and_b32 v2, 31, v0
    v_lshrrev_b32 v3, 5, v0
    v_lshlrev_b32 v3, 2, v3
    v_sub_u32 v2, v2, v3
    v_cmp_le_i32 s[68:69], 0, v2
    v_cmp_le_i32 s[70:71], 1, v2
    v_cmp_le_i32 s[72:73], 2, v2
    v_cmp_le_i32 s[74:75], 3, v2
    v_cmp_le_i32 s[76:77], 8, v2
    v_cmp_le_i32 s[78:79], 9, v2
    v_cmp_le_i32 s[80:81], 10, v2
    v_cmp_le_i32 s[82:83], 11, v2
    v_cmp_le_i32 s[84:85], 16, v2
    v_cmp_le_i32 s[86:87], 17, v2
    v_cmp_le_i32 s[88:89], 18, v2
    v_cmp_le_i32 s[90:91], 19, v2
    v_cmp_le_i32 s[92:93], 24, v2
    v_cmp_le_i32 s[94:95], 25, v2
    v_cmp_le_i32 s[96:97], 26, v2
    v_cmp_le_i32 s[98:99], 27, v2
    s_mul_i32 s28, s9, 7
    s_lshr_b32 s28, s28, 1
    s_lshl_b32 s11, s8, 2
    s_add_u32 s12, s11, s3
    s_mul_i32 s13, s3, 3
    s_add_u32 s11, s11, s13
    s_sub_i32 s18, s11, 8
    s_max_i32 s13, s18, 0
    s_lshl_b32 s13, s13, 14
    s_add_u32 s13, s13, 22423552
    s_lshl_b32 s14, s12, 14
    s_add_u32 s14, s14, 22423552
    s_add_u32 s15, s28, 0
    s_lshr_b32 s15, s15, 2
    s_lshl_b32 s15, s15, 10
    s_add_u32 s20, s15, s13
    s_add_u32 s22, s15, s14
    s_add_u32 s15, s28, 3
    s_lshr_b32 s15, s15, 2
    s_lshl_b32 s15, s15, 10
    s_add_u32 s21, s15, s13
    s_add_u32 s23, s15, s14
    s_mov_b32 s24, s12
    s_lshl_b32 s28, s28, 9
    s_mul_i32 s19, s12, 86016
    s_add_u32 s19, s19, s28
    s_add_i32 s13, s18, 0
    s_mul_i32 s14, s13, 86016
    s_add_u32 s14, s14, s28
    s_add_u32 s14, s14, 28672
    s_cmp_lt_i32 s13, 0
    s_cselect_b32 s29, 2146435072, s14
    s_add_i32 s13, s18, 1
    s_mul_i32 s14, s13, 86016
    s_add_u32 s14, s14, s28
    s_add_u32 s14, s14, 28672
    s_cmp_lt_i32 s13, 0
    s_cselect_b32 s30, 2146435072, s14
    s_add_i32 s13, s18, 2
    s_mul_i32 s14, s13, 86016
    s_add_u32 s14, s14, s28
    s_add_u32 s14, s14, 28672
    s_cmp_lt_i32 s13, 0
    s_cselect_b32 s31, 2146435072, s14
    s_mul_i32 s17, s3, 12288
    v_lshrrev_b32 v5, 5, v0
    v_lshlrev_b32 v5, 6, v5
    v_xor_b32 v4, v1, v5
    v_xor_b32 v5, 128, v4
    s_bitcmp1_b32 s9, 0
    s_cselect_b64 s[26:27], -1, 0
    s_min_u32 s18, s7, 6
    s_lshl_b32 s18, s18, 2
    s_and_b32 s11, s3, 2
    s_add_u32 s18, s18, s11
    s_lshl_b32 s18, s18, 8
    s_add_u32 s18, s18, 24840192
    v_and_b32 v15, 31, v0
    v_mul_u32_u24 v15, 896, v15
    v_lshrrev_b32 v2, 5, v0
    v_lshl_add_u32 v15, v2, 4, v15
    s_lshl_b32 s1, s6, 1
    s_and_b32 s12, s3, 1
    s_add_u32 s1, s1, s12
    s_mul_i32 s1, s1, 28672
    s_lshl_b32 s12, s7, 7
    s_add_u32 s1, s1, s12
    s_lshr_b32 s12, s3, 1
    s_lshl_b32 s12, s12, 6
    s_add_u32 s1, s1, s12
    v_lshrrev_b32 v220, 3, v0
    v_and_b32 v221, 7, v0
    v_mul_u32_u24 v220, 3584, v220
    v_lshl_add_u32 v220, v221, 4, v220
    v_add_u32 v221, 27648, v220
    s_lshl_b32 s25, s7, 6
    s_lshl_b32 s28, s3, 4
    s_add_u32 s25, s25, s28
    s_mul_i32 s25, s25, 3584
    s_lshl_b32 s28, s6, 7
    s_add_u32 s25, s25, s28
    s_cmp_lt_u32 s6, 28
    s_cselect_b32 s25, s25, 2146435072
    s_lshl_b32 s28, s3, 11
    s_load_dword s50, s[32:33], 0x0
    s_waitcnt lgkmcnt(0)
    s_cmp_lg_u32 s50, 0
    s_cbranch_scc0 L_ep_57
L_epd_58:
    s_mov_b32 s51, s50
    v_mov_b32 v250, s50
    v_mov_b32 v251, s50
    v_mov_b32 v252, s50
    v_mov_b32 v253, s50
    s_waitcnt vmcnt(14)
    s_barrier
    s_mov_b32 s11, s6
    s_lshl_b32 s11, s11, 8
    s_add_u32 s11, s11, 24840192
    s_cmp_eq_u32 s3, 0
    s_cselect_b32 s11, s11, 2146435072
    s_mov_b64 exec, 0xffff
    buffer_store_dwordx4 v[250:253], v1, s[40:43], s11 offen sc1
    s_mov_b64 exec, -1
    s_waitcnt vmcnt(1)
    ds_read_b64_tr_b16 v[48:49], v110 offset:18432
    ds_read_b64_tr_b16 v[50:51], v110 offset:22016
    ds_read_b64_tr_b16 v[52:53], v110 offset:18496
    ds_read_b64_tr_b16 v[54:55], v110 offset:22080
    ds_read_b64_tr_b16 v[56:57], v110 offset:18560
    ds_read_b64_tr_b16 v[58:59], v110 offset:22144
    ds_read_b64_tr_b16 v[60:61], v110 offset:18624
    ds_read_b64_tr_b16 v[62:63], v110 offset:22208
    ds_read_b64_tr_b16 v[64:65], v110 offset:18688
    ds_read_b64_tr_b16 v[66:67], v110 offset:22272
    ds_read_b64_tr_b16 v[68:69], v110 offset:18752
    ds_read_b64_tr_b16 v[70:71], v110 offset:22336
    ds_read_b64_tr_b16 v[72:73], v110 offset:18816
    ds_read_b64_tr_b16 v[74:75], v110 offset:22400
    ds_read_b64_tr_b16 v[76:77], v110 offset:18880
    ds_read_b64_tr_b16 v[78:79], v110 offset:22464
    ds_read_b64_tr_b16 v[80:81], v110 offset:18944
    ds_read_b64_tr_b16 v[82:83], v110 offset:22528
    ds_read_b64_tr_b16 v[84:85], v110 offset:19008
    ds_read_b64_tr_b16 v[86:87], v110 offset:22592
    ds_read_b64_tr_b16 v[88:89], v110 offset:19072
    ds_read_b64_tr_b16 v[90:91], v110 offset:22656
    ds_read_b64_tr_b16 v[92:93], v110 offset:19136
    ds_read_b64_tr_b16 v[94:95], v110 offset:22720
    ds_read_b64_tr_b16 v[96:97], v110 offset:19200
    ds_read_b64_tr_b16 v[98:99], v110 offset:22784
    ds_read_b64_tr_b16 v[100:101], v110 offset:19264
    ds_read_b64_tr_b16 v[102:103], v110 offset:22848
    s_waitcnt lgkmcnt(15)
    buffer_store_dwordx4 v[48:51], v1, s[40:43], s0 offen offset:0 sc1
    buffer_store_dwordx4 v[52:55], v1, s[40:43], s0 offen offset:1024 sc1
    s_add_u32 s0, s0, 229376
    buffer_store_dwordx4 v[56:59], v1, s[40:43], s0 offen offset:0 sc1
    buffer_store_dwordx4 v[60:63], v1, s[40:43], s0 offen offset:1024 sc1
    s_add_u32 s0, s0, 229376
    buffer_store_dwordx4 v[64:67], v1, s[40:43], s0 offen offset:0 sc1
    buffer_store_dwordx4 v[68:71], v1, s[40:43], s0 offen offset:1024 sc1
    s_add_u32 s0, s0, 229376
    s_waitcnt lgkmcnt(14)
    buffer_store_dwordx4 v[72:75], v1, s[40:43], s0 offen offset:0 sc1
    s_waitcnt lgkmcnt(12)
    buffer_store_dwordx4 v[76:79], v1, s[40:43], s0 offen offset:1024 sc1
    s_add_u32 s0, s0, 229376
    s_waitcnt lgkmcnt(10)
    buffer_store_dwordx4 v[80:83], v1, s[40:43], s0 offen offset:0 sc1
    s_waitcnt lgkmcnt(8)
    buffer_store_dwordx4 v[84:87], v1, s[40:43], s0 offen offset:1024 sc1
    s_add_u32 s0, s0, 229376
    s_waitcnt lgkmcnt(6)
    buffer_store_dwordx4 v[88:91], v1, s[40:43], s0 offen offset:0 sc1
    s_waitcnt lgkmcnt(4)
    buffer_store_dwordx4 v[92:95], v1, s[40:43], s0 offen offset:1024 sc1
    s_add_u32 s0, s0, 229376
    s_waitcnt lgkmcnt(2)
    buffer_store_dwordx4 v[96:99], v1, s[40:43], s0 offen offset:0 sc1
    s_waitcnt lgkmcnt(0)
    buffer_store_dwordx4 v[100:103], v1, s[40:43], s0 offen offset:1024 sc1
    s_lshl_b32 s0, s6, 15
    s_add_u32 s0, s0, 22429952
    s_load_dword s12, s[34:35], s0 offset:128
    s_waitcnt vmcnt(0)
    s_barrier
    s_mov_b32 s11, s6
    s_lshl_b32 s11, s11, 8
    s_add_u32 s11, s11, 24848384
    s_cmp_eq_u32 s3, 0
    s_cselect_b32 s11, s11, 2146435072
    s_mov_b64 exec, 0xffff
    buffer_store_dwordx4 v[250:253], v1, s[40:43], s11 offen sc1
    s_mov_b64 exec, -1
    s_waitcnt lgkmcnt(0)
    s_cmp_eq_u32 s12, s50
    s_cbranch_scc1 L_nopw
    s_cmp_lg_u32 s3, 0
    s_cbranch_scc1 L_nopw
    s_waitcnt vmcnt(0)
L_pw_59:
    buffer_load_dword v255, off, s[40:43], s0 offset:192 sc1
    s_waitcnt vmcnt(0)
    v_cmp_ne_u32 vcc, s50, v255
    s_nop 4
    s_cbranch_vccz L_pwd_60
    s_sub_u32 s10, s10, 1
    s_cbranch_scc1 L_exit
    s_sleep 8
    s_branch L_pw_59
L_pwd_60:
L_nopw:
    s_barrier
    s_load_dword s52, s[34:35], s20 offset:0
    s_load_dword s53, s[34:35], s20 offset:16384
    s_load_dword s54, s[34:35], s20 offset:32768
    s_load_dword s55, s[34:35], s21 offset:0
    s_load_dword s56, s[34:35], s21 offset:16384
    s_load_dword s57, s[34:35], s21 offset:32768
    s_load_dword s58, s[34:35], s22 offset:256
    s_load_dword s59, s[34:35], s23 offset:256
    s_mov_b64 s[14:15], s[34:35]
    s_mov_b32 s13, 3
L_poll_61:
    s_waitcnt lgkmcnt(0)
    s_xor_b64 s[52:53], s[52:53], s[50:51]
    s_xor_b64 s[54:55], s[54:55], s[50:51]
    s_or_b64 s[52:53], s[52:53], s[54:55]
    s_xor_b64 s[56:57], s[56:57], s[50:51]
    s_or_b64 s[52:53], s[52:53], s[56:57]
    s_xor_b64 s[58:59], s[58:59], s[50:51]
    s_or_b64 s[52:53], s[52:53], s[58:59]
    s_cbranch_scc0 L_pdone_62
    s_sub_u32 s13, s13, 1
    s_cbranch_scc1 L_pslow_63
    s_sleep 4
    s_add_u32 s14, s14, 64
    s_addc_u32 s15, s15, 0
    s_load_dword s52, s[14:15], s20 offset:0
    s_load_dword s53, s[14:15], s20 offset:16384
    s_load_dword s54, s[14:15], s20 offset:32768
    s_load_dword s55, s[14:15], s21 offset:0
    s_load_dword s56, s[14:15], s21 offset:16384
    s_load_dword s57, s[14:15], s21 offset:32768
    s_load_dword s58, s[14:15], s22 offset:256
    s_load_dword s59, s[14:15], s23 offset:256
    s_branch L_poll_61
L_pdone_62:
    s_add_u32 m0, s17, 114688
    s_nop 0
    buffer_load_dwordx4 v1, s[40:43], s29 offen offset:0 sc1 lds
    buffer_load_dwordx4 v1, s[40:43], s29 offen offset:1024 sc1 lds
    s_add_u32 m0, s17, 118784
    s_nop 0
    buffer_load_dwordx4 v1, s[40:43], s30 offen offset:0 sc1 lds
    buffer_load_dwordx4 v1, s[40:43], s30 offen offset:1024 sc1 lds
    s_add_u32 m0, s17, 122880
    s_nop 0
    buffer_load_dwordx4 v1, s[40:43], s31 offen offset:0 sc1 lds
    buffer_load_dwordx4 v1, s[40:43], s31 offen offset:1024 sc1 lds
    s_mov_b32 s11, s1
    s_branch L_join1
L_p5slow:
    s_nop 15
    v_pk_mul_f32 v[224:225], v[144:145], v[144:145]
    v_pk_mul_f32 v[226:227], v[146:147], v[146:147]
    v_pk_mul_f32 v[228:229], v[148:149], v[148:149]
    v_pk_mul_f32 v[230:231], v[150:151], v[150:151]
    v_pk_fma_f32 v[224:225], v[224:225], v[10:11], v[8:9] op_sel:[0,0,1] op_sel_hi:[1,0,1]
    v_pk_fma_f32 v[226:227], v[226:227], v[10:11], v[8:9] op_sel:[0,0,1] op_sel_hi:[1,0,1]
    v_pk_fma_f32 v[228:229], v[228:229], v[10:11], v[8:9] op_sel:[0,0,1] op_sel_hi:[1,0,1]
    v_pk_fma_f32 v[230:231], v[230:231], v[10:11], v[8:9] op_sel:[0,0,1] op_sel_hi:[1,0,1]
    v_pk_mul_f32 v[152:153], v[144:145], v[152:153]
    v_pk_mul_f32 v[154:155], v[146:147], v[154:155]
    v_pk_mul_f32 v[156:157], v[148:149], v[156:157]
    v_pk_mul_f32 v[158:159], v[150:151], v[158:159]
    v_pk_mul_f32 v[144:145], v[224:225], v[144:145]
    v_pk_mul_f32 v[146:147], v[226:227], v[146:147]
    v_pk_mul_f32 v[148:149], v[228:229], v[148:149]
    v_pk_mul_f32 v[150:151], v[230:231], v[150:151]
    v_exp_f32 v144, v144
    v_exp_f32 v145, v145
    v_exp_f32 v146, v146
    v_exp_f32 v147, v147
    v_exp_f32 v148, v148
    v_exp_f32 v149, v149
    v_exp_f32 v150, v150
    v_exp_f32 v151, v151
    v_pk_fma_f32 v[144:145], v[144:145], v[10:11], v[10:11] op_sel:[0,1,1] op_sel_hi:[1,1,1]
    v_pk_fma_f32 v[146:147], v[146:147], v[10:11], v[10:11] op_sel:[0,1,1] op_sel_hi:[1,1,1]
    v_pk_fma_f32 v[148:149], v[148:149], v[10:11], v[10:11] op_sel:[0,1,1] op_sel_hi:[1,1,1]
    v_pk_fma_f32 v[150:151], v[150:151], v[10:11], v[10:11] op_sel:[0,1,1] op_sel_hi:[1,1,1]
    v_rcp_f32 v144, v144
    v_rcp_f32 v145, v145
    v_rcp_f32 v146, v146
    v_rcp_f32 v147, v147
    v_rcp_f32 v148, v148
    v_rcp_f32 v149, v149
    v_rcp_f32 v150, v150
    v_rcp_f32 v151, v151
    v_pk_mul_f32 v[144:145], v[144:145], v[152:153]
    v_pk_mul_f32 v[146:147], v[146:147], v[154:155]
    v_pk_mul_f32 v[148:149], v[148:149], v[156:157]
    v_pk_mul_f32 v[150:151], v[150:151], v[158:159]
    v_cvt_pk_bf16_f32 v232, v144, v145
    v_cvt_pk_bf16_f32 v233, v146, v147
    v_cvt_pk_bf16_f32 v234, v148, v149
    v_cvt_pk_bf16_f32 v235, v150, v151
    buffer_store_dwordx4 v[232:235], v1, s[40:43], s28 offen offset:2048 sc1
    s_waitcnt vmcnt(0)
    s_mov_b32 s11, s27
    s_lshl_b32 s11, s11, 10
    s_add_u32 s11, s11, 23472640
    s_mov_b64 exec, 0xffff
    buffer_store_dwordx4 v[250:253], v1, s[40:43], s11 offen sc1
    s_mov_b64 exec, -1
    s_add_u32 s20, s20, 128
    s_load_dword s52, s[34:35], s20 offset:0
    s_load_dword s53, s[34:35], s20 offset:1024
    s_load_dword s54, s[34:35], s20 offset:2048
    s_load_dword s55, s[34:35], s20 offset:3072
    s_load_dword s56, s[34:35], s20 offset:16384
    s_load_dword s57, s[34:35], s20 offset:17408
    s_load_dword s58, s[34:35], s20 offset:18432
    s_load_dword s59, s[34:35], s20 offset:19456
    s_mov_b64 s[14:15], s[34:35]
    s_mov_b32 s13, 1
L_poll_40:
    s_waitcnt lgkmcnt(0)
    s_xor_b64 s[52:53], s[52:53], s[50:51]
    s_xor_b64 s[54:55], s[54:55], s[50:51]
    s_or_b64 s[52:53], s[52:53], s[54:55]
    s_xor_b64 s[56:57], s[56:57], s[50:51]
    s_or_b64 s[52:53], s[52:53], s[56:57]
    s_xor_b64 s[58:59], s[58:59], s[50:51]
    s_or_b64 s[52:53], s[52:53], s[58:59]
    s_cbranch_scc0 L_pdone_41
    s_sub_u32 s13, s13, 1
    s_cbranch_scc1 L_pslow_42
    s_sleep 4
    s_add_u32 s14, s14, 64
    s_addc_u32 s15, s15, 0
    s_load_dword s52, s[14:15], s20 offset:0
    s_load_dword s53, s[14:15], s20 offset:1024
    s_load_dword s54, s[14:15], s20 offset:2048
    s_load_dword s55, s[14:15], s20 offset:3072
    s_load_dword s56, s[14:15], s20 offset:16384
    s_load_dword s57, s[14:15], s20 offset:17408
    s_load_dword s58, s[14:15], s20 offset:18432
    s_load_dword s59, s[14:15], s20 offset:19456
    s_branch L_poll_40
L_pdone_41:
    s_sub_u32 s20, s20, 128
    buffer_load_dwordx4 v[160:163], v1, s[40:43], s68 offen offset:0 sc1
    buffer_load_dwordx4 v[164:167], v1, s[40:43], s76 offen offset:0 sc1
    buffer_load_dwordx4 v[168:171], v1, s[40:43], s69 offen offset:3072 sc1
    buffer_load_dwordx4 v[172:175], v1, s[40:43], s77 offen offset:3072 sc1
    buffer_load_dwordx4 v[176:179], v1, s[40:43], s71 offen offset:2048 sc1
    buffer_load_dwordx4 v[180:183], v1, s[40:43], s79 offen offset:2048 sc1
    buffer_load_dwordx4 v[184:187], v1, s[40:43], s73 offen offset:1024 sc1
    buffer_load_dwordx4 v[188:191], v1, s[40:43], s81 offen offset:1024 sc1
    s_waitcnt vmcnt(0)
    s_branch L_p5join
    L_ep_1:
    v_mov_b32 v255, 0
    L_ep_1_l:
    global_load_dword v253, v255, s[32:33] sc1
    s_waitcnt vmcnt(0)
    v_readfirstlane_b32 s50, v253
    s_nop 4
    s_cmp_lg_u32 s50, 0
    s_cbranch_scc1 L_epd_2
    s_sub_u32 s10, s10, 1
    s_cbranch_scc1 L_exit
    s_sleep 4
    s_branch L_ep_1_l
    L_pslow_5:
    v_mov_b32 v255, 0
    s_add_u32 s13, s20, 0
    v_writelane_b32 v255, s13, 0
    s_add_u32 s13, s20, 16384
    v_writelane_b32 v255, s13, 1
    s_add_u32 s13, s20, 32768
    v_writelane_b32 v255, s13, 2
    s_add_u32 s13, s21, 0
    v_writelane_b32 v255, s13, 3
    s_add_u32 s13, s21, 16384
    v_writelane_b32 v255, s13, 4
    s_add_u32 s13, s21, 32768
    v_writelane_b32 v255, s13, 5
    s_mov_b64 exec, 0x3f
    L_pslow_5_l:
    buffer_load_dword v253, v255, s[40:43], 0 offen sc1
    s_waitcnt vmcnt(0)
    v_cmp_ne_u32 vcc, s50, v253
    s_nop 4
    s_cbranch_vccz L_pslow_5_d
    s_sub_u32 s10, s10, 1
    s_cbranch_scc1 L_exit
    s_sleep 6
    s_branch L_pslow_5_l
    L_pslow_5_d:
    v_mov_b32 v253, s50
    s_mov_b64 exec, -1
    s_nop 4
    s_branch L_pdone_4
    L_pslow_8:
    v_mov_b32 v255, 0
    s_add_u32 s13, s22, 256
    v_writelane_b32 v255, s13, 0
    s_add_u32 s13, s23, 256
    v_writelane_b32 v255, s13, 1
    s_add_u32 s13, s18, 0
    v_writelane_b32 v255, s13, 2
    s_add_u32 s13, s18, 256
    v_writelane_b32 v255, s13, 3
    s_mov_b64 exec, 0xf
    L_pslow_8_l:
    buffer_load_dword v253, v255, s[40:43], 0 offen sc1
    s_waitcnt vmcnt(0)
    v_cmp_ne_u32 vcc, s50, v253
    s_nop 4
    s_cbranch_vccz L_pslow_8_d
    s_sub_u32 s10, s10, 1
    s_cbranch_scc1 L_exit
    s_sleep 6
    s_branch L_pslow_8_l
    L_pslow_8_d:
    v_mov_b32 v253, s50
    s_mov_b64 exec, -1
    s_nop 4
    s_branch L_pdone_7
    L_fill_9:
    s_nop 15
    v_mov_b32 v16, 0xff800000
    v_mov_b32 v17, 0xff800000
    v_mov_b32 v18, 0xff800000
    v_mov_b32 v19, 0xff800000
    v_mov_b32 v20, 0xff800000
    v_mov_b32 v21, 0xff800000
    v_mov_b32 v22, 0xff800000
    v_mov_b32 v23, 0xff800000
    v_mov_b32 v24, 0xff800000
    v_mov_b32 v25, 0xff800000
    v_mov_b32 v26, 0xff800000
    v_mov_b32 v27, 0xff800000
    v_mov_b32 v28, 0xff800000
    v_mov_b32 v29, 0xff800000
    v_mov_b32 v30, 0xff800000
    v_mov_b32 v31, 0xff800000
    s_branch L_fill_9_r
    L_fillr_24:
    s_nop 15
    v_mov_b32 v32, 0xff800000
    v_mov_b32 v33, 0xff800000
    v_mov_b32 v34, 0xff800000
    v_mov_b32 v35, 0xff800000
    v_mov_b32 v36, 0xff800000
    v_mov_b32 v37, 0xff800000
    v_mov_b32 v38, 0xff800000
    v_mov_b32 v39, 0xff800000
    v_mov_b32 v40, 0xff800000
    v_mov_b32 v41, 0xff800000
    v_mov_b32 v42, 0xff800000
    v_mov_b32 v43, 0xff800000
    v_mov_b32 v44, 0xff800000
    v_mov_b32 v45, 0xff800000
    v_mov_b32 v46, 0xff800000
    v_mov_b32 v47, 0xff800000
    s_cmp_lt_u32 s24, 6
    s_cbranch_scc0 L_fillr_24_r
    v_mov_b32 v48, 0xff800000
    v_mov_b32 v49, 0xff800000
    v_mov_b32 v50, 0xff800000
    v_mov_b32 v51, 0xff800000
    v_mov_b32 v52, 0xff800000
    v_mov_b32 v53, 0xff800000
    v_mov_b32 v54, 0xff800000
    v_mov_b32 v55, 0xff800000
    v_mov_b32 v56, 0xff800000
    v_mov_b32 v57, 0xff800000
    v_mov_b32 v58, 0xff800000
    v_mov_b32 v59, 0xff800000
    v_mov_b32 v60, 0xff800000
    v_mov_b32 v61, 0xff800000
    v_mov_b32 v62, 0xff800000
    v_mov_b32 v63, 0xff800000
    s_cmp_lt_u32 s24, 5
    s_cbranch_scc0 L_fillr_24_r
    v_mov_b32 v64, 0xff800000
    v_mov_b32 v65, 0xff800000
    v_mov_b32 v66, 0xff800000
    v_mov_b32 v67, 0xff800000
    v_mov_b32 v68, 0xff800000
    v_mov_b32 v69, 0xff800000
    v_mov_b32 v70, 0xff800000
    v_mov_b32 v71, 0xff800000
    v_mov_b32 v72, 0xff800000
    v_mov_b32 v73, 0xff800000
    v_mov_b32 v74, 0xff800000
    v_mov_b32 v75, 0xff800000
    v_mov_b32 v76, 0xff800000
    v_mov_b32 v77, 0xff800000
    v_mov_b32 v78, 0xff800000
    v_mov_b32 v79, 0xff800000
    s_cmp_lt_u32 s24, 4
    s_cbranch_scc0 L_fillr_24_r
    v_mov_b32 v80, 0xff800000
    v_mov_b32 v81, 0xff800000
    v_mov_b32 v82, 0xff800000
    v_mov_b32 v83, 0xff800000
    v_mov_b32 v84, 0xff800000
    v_mov_b32 v85, 0xff800000
    v_mov_b32 v86, 0xff800000
    v_mov_b32 v87, 0xff800000
    v_mov_b32 v88, 0xff800000
    v_mov_b32 v89, 0xff800000
    v_mov_b32 v90, 0xff800000
    v_mov_b32 v91, 0xff800000
    v_mov_b32 v92, 0xff800000
    v_mov_b32 v93, 0xff800000
    v_mov_b32 v94, 0xff800000
    v_mov_b32 v95, 0xff800000
    s_cmp_lt_u32 s24, 3
    s_cbranch_scc0 L_fillr_24_r
    v_mov_b32 v96, 0xff800000
    v_mov_b32 v97, 0xff800000
    v_mov_b32 v98, 0xff800000
    v_mov_b32 v99, 0xff800000
    v_mov_b32 v100, 0xff800000
    v_mov_b32 v101, 0xff800000
    v_mov_b32 v102, 0xff800000
    v_mov_b32 v103, 0xff800000
    v_mov_b32 v104, 0xff800000
    v_mov_b32 v105, 0xff800000
    v_mov_b32 v106, 0xff800000
    v_mov_b32 v107, 0xff800000
    v_mov_b32 v108, 0xff800000
    v_mov_b32 v109, 0xff800000
    v_mov_b32 v110, 0xff800000
    v_mov_b32 v111, 0xff800000
    s_cmp_lt_u32 s24, 2
    s_cbranch_scc0 L_fillr_24_r
    v_mov_b32 v112, 0xff800000
    v_mov_b32 v113, 0xff800000
    v_mov_b32 v114, 0xff800000
    v_mov_b32 v115, 0xff800000
    v_mov_b32 v116, 0xff800000
    v_mov_b32 v117, 0xff800000
    v_mov_b32 v118, 0xff800000
    v_mov_b32 v119, 0xff800000
    v_mov_b32 v120, 0xff800000
    v_mov_b32 v121, 0xff800000
    v_mov_b32 v122, 0xff800000
    v_mov_b32 v123, 0xff800000
    v_mov_b32 v124, 0xff800000
    v_mov_b32 v125, 0xff800000
    v_mov_b32 v126, 0xff800000
    v_mov_b32 v127, 0xff800000
    s_cmp_lt_u32 s24, 1
    s_cbranch_scc0 L_fillr_24_r
    v_mov_b32 v128, 0xff800000
    v_mov_b32 v129, 0xff800000
    v_mov_b32 v130, 0xff800000
    v_mov_b32 v131, 0xff800000
    v_mov_b32 v132, 0xff800000
    v_mov_b32 v133, 0xff800000
    v_mov_b32 v134, 0xff800000
    v_mov_b32 v135, 0xff800000
    v_mov_b32 v136, 0xff800000
    v_mov_b32 v137, 0xff800000
    v_mov_b32 v138, 0xff800000
    v_mov_b32 v139, 0xff800000
    v_mov_b32 v140, 0xff800000
    v_mov_b32 v141, 0xff800000
    v_mov_b32 v142, 0xff800000
    v_mov_b32 v143, 0xff800000
    s_branch L_fillr_24_r
    L_pslow_27:
    v_mov_b32 v255, 0
    s_add_u32 s13, s20, 512
    v_writelane_b32 v255, s13, 0
    s_add_u32 s13, s20, 16896
    v_writelane_b32 v255, s13, 1
    s_add_u32 s13, s20, 33280
    v_writelane_b32 v255, s13, 2
    s_add_u32 s13, s21, 512
    v_writelane_b32 v255, s13, 3
    s_add_u32 s13, s21, 16896
    v_writelane_b32 v255, s13, 4
    s_add_u32 s13, s21, 33280
    v_writelane_b32 v255, s13, 5
    s_mov_b64 exec, 0x3f
    L_pslow_27_l:
    buffer_load_dword v253, v255, s[40:43], 0 offen sc1
    s_waitcnt vmcnt(0)
    v_cmp_ne_u32 vcc, s50, v253
    s_nop 4
    s_cbranch_vccz L_pslow_27_d
    s_sub_u32 s10, s10, 1
    s_cbranch_scc1 L_exit
    s_sleep 6
    s_branch L_pslow_27_l
    L_pslow_27_d:
    v_mov_b32 v253, s50
    s_mov_b64 exec, -1
    s_nop 4
    s_branch L_pdone_26
    L_pslow_30:
    v_mov_b32 v255, 0
    s_add_u32 s13, s22, 0
    v_writelane_b32 v255, s13, 0
    s_add_u32 s13, s22, 256
    v_writelane_b32 v255, s13, 1
    s_add_u32 s13, s22, 512
    v_writelane_b32 v255, s13, 2
    s_add_u32 s13, s22, 768
    v_writelane_b32 v255, s13, 3
    s_add_u32 s13, s22, 1024
    v_writelane_b32 v255, s13, 4
    s_add_u32 s13, s22, 1280
    v_writelane_b32 v255, s13, 5
    s_add_u32 s13, s22, 1536
    v_writelane_b32 v255, s13, 6
    s_mov_b64 exec, 0x7f
    L_pslow_30_l:
    buffer_load_dword v253, v255, s[40:43], 0 offen sc1
    s_waitcnt vmcnt(0)
    v_cmp_ne_u32 vcc, s50, v253
    s_nop 4
    s_cbranch_vccz L_pslow_30_d
    s_sub_u32 s10, s10, 1
    s_cbranch_scc1 L_exit
    s_sleep 6
    s_branch L_pslow_30_l
    L_pslow_30_d:
    v_mov_b32 v253, s50
    s_mov_b64 exec, -1
    s_nop 4
    s_branch L_pdone_29
    L_pslow_33:
    v_mov_b32 v255, 0
    s_add_u32 s13, s20, 0
    v_writelane_b32 v255, s13, 0
    s_add_u32 s13, s20, 256
    v_writelane_b32 v255, s13, 1
    s_add_u32 s13, s20, 512
    v_writelane_b32 v255, s13, 2
    s_add_u32 s13, s20, 768
    v_writelane_b32 v255, s13, 3
    s_add_u32 s13, s20, 1024
    v_writelane_b32 v255, s13, 4
    s_add_u32 s13, s20, 1280
    v_writelane_b32 v255, s13, 5
    s_add_u32 s13, s20, 1536
    v_writelane_b32 v255, s13, 6
    s_add_u32 s13, s20, 1792
    v_writelane_b32 v255, s13, 7
    s_mov_b64 exec, 0xff
    L_pslow_33_l:
    buffer_load_dword v253, v255, s[40:43], 0 offen sc1
    s_waitcnt vmcnt(0)
    v_cmp_ne_u32 vcc, s50, v253
    s_nop 4
    s_cbranch_vccz L_pslow_33_d
    s_sub_u32 s10, s10, 1
    s_cbranch_scc1 L_exit
    s_sleep 6
    s_branch L_pslow_33_l
    L_pslow_33_d:
    v_mov_b32 v253, s50
    s_mov_b64 exec, -1
    s_nop 4
    s_branch L_pdone_32
    L_pslow_36:
    v_mov_b32 v255, 0
    s_add_u32 s13, s23, 0
    v_writelane_b32 v255, s13, 0
    s_add_u32 s13, s23, 256
    v_writelane_b32 v255, s13, 1
    s_add_u32 s13, s23, 512
    v_writelane_b32 v255, s13, 2
    s_add_u32 s13, s23, 1792
    v_writelane_b32 v255, s13, 3
    s_add_u32 s13, s23, 2048
    v_writelane_b32 v255, s13, 4
    s_add_u32 s13, s23, 2304
    v_writelane_b32 v255, s13, 5
    s_add_u32 s13, s23, 3584
    v_writelane_b32 v255, s13, 6
    s_add_u32 s13, s23, 3840
    v_writelane_b32 v255, s13, 7
    s_add_u32 s13, s23, 4096
    v_writelane_b32 v255, s13, 8
    s_mov_b64 exec, 0x1ff
    L_pslow_36_l:
    buffer_load_dword v253, v255, s[40:43], 0 offen sc1
    s_waitcnt vmcnt(0)
    v_cmp_ne_u32 vcc, s50, v253
    s_nop 4
    s_cbranch_vccz L_pslow_36_d
    s_sub_u32 s10, s10, 1
    s_cbranch_scc1 L_exit
    s_sleep 6
    s_branch L_pslow_36_l
    L_pslow_36_d:
    v_mov_b32 v253, s50
    s_mov_b64 exec, -1
    s_nop 4
    s_branch L_pdone_35
    L_pslow_39:
    v_mov_b32 v255, 0
    s_add_u32 s13, s20, 0
    v_writelane_b32 v255, s13, 0
    s_add_u32 s13, s20, 1024
    v_writelane_b32 v255, s13, 1
    s_add_u32 s13, s20, 2048
    v_writelane_b32 v255, s13, 2
    s_add_u32 s13, s20, 3072
    v_writelane_b32 v255, s13, 3
    s_add_u32 s13, s20, 4096
    v_writelane_b32 v255, s13, 4
    s_add_u32 s13, s20, 5120
    v_writelane_b32 v255, s13, 5
    s_add_u32 s13, s20, 6144
    v_writelane_b32 v255, s13, 6
    s_add_u32 s13, s20, 7168
    v_writelane_b32 v255, s13, 7
    s_add_u32 s13, s20, 8192
    v_writelane_b32 v255, s13, 8
    s_add_u32 s13, s20, 9216
    v_writelane_b32 v255, s13, 9
    s_add_u32 s13, s20, 10240
    v_writelane_b32 v255, s13, 10
    s_add_u32 s13, s20, 11264
    v_writelane_b32 v255, s13, 11
    s_add_u32 s13, s20, 12288
    v_writelane_b32 v255, s13, 12
    s_add_u32 s13, s20, 13312
    v_writelane_b32 v255, s13, 13
    s_mov_b64 exec, 0x3fff
    L_pslow_39_l:
    buffer_load_dword v253, v255, s[40:43], 0 offen sc1
    s_waitcnt vmcnt(0)
    v_cmp_ne_u32 vcc, s50, v253
    s_nop 4
    s_cbranch_vccz L_pslow_39_d
    s_sub_u32 s10, s10, 1
    s_cbranch_scc1 L_exit
    s_sleep 6
    s_branch L_pslow_39_l
    L_pslow_39_d:
    v_mov_b32 v253, s50
    s_mov_b64 exec, -1
    s_nop 4
    s_branch L_pdone_38
    L_pslow_42:
    v_mov_b32 v255, 0
    s_add_u32 s13, s20, 0
    v_writelane_b32 v255, s13, 0
    s_add_u32 s13, s20, 1024
    v_writelane_b32 v255, s13, 1
    s_add_u32 s13, s20, 2048
    v_writelane_b32 v255, s13, 2
    s_add_u32 s13, s20, 3072
    v_writelane_b32 v255, s13, 3
    s_add_u32 s13, s20, 16384
    v_writelane_b32 v255, s13, 4
    s_add_u32 s13, s20, 17408
    v_writelane_b32 v255, s13, 5
    s_add_u32 s13, s20, 18432
    v_writelane_b32 v255, s13, 6
    s_add_u32 s13, s20, 19456
    v_writelane_b32 v255, s13, 7
    s_mov_b64 exec, 0xff
    L_pslow_42_l:
    buffer_load_dword v253, v255, s[40:43], 0 offen sc1
    s_waitcnt vmcnt(0)
    v_cmp_ne_u32 vcc, s50, v253
    s_nop 4
    s_cbranch_vccz L_pslow_42_d
    s_sub_u32 s10, s10, 1
    s_cbranch_scc1 L_exit
    s_sleep 6
    s_branch L_pslow_42_l
    L_pslow_42_d:
    v_mov_b32 v253, s50
    s_mov_b64 exec, -1
    s_nop 4
    s_branch L_pdone_41
    L_pslow_45:
    v_mov_b32 v255, 0
    s_add_u32 s13, s20, 256
    v_writelane_b32 v255, s13, 0
    s_add_u32 s13, s20, 1280
    v_writelane_b32 v255, s13, 1
    s_add_u32 s13, s20, 2304
    v_writelane_b32 v255, s13, 2
    s_add_u32 s13, s20, 3328
    v_writelane_b32 v255, s13, 3
    s_add_u32 s13, s20, 16640
    v_writelane_b32 v255, s13, 4
    s_add_u32 s13, s20, 17664
    v_writelane_b32 v255, s13, 5
    s_add_u32 s13, s20, 18688
    v_writelane_b32 v255, s13, 6
    s_add_u32 s13, s20, 19712
    v_writelane_b32 v255, s13, 7
    s_mov_b64 exec, 0xff
    L_pslow_45_l:
    buffer_load_dword v253, v255, s[40:43], 0 offen sc1
    s_waitcnt vmcnt(0)
    v_cmp_ne_u32 vcc, s50, v253
    s_nop 4
    s_cbranch_vccz L_pslow_45_d
    s_sub_u32 s10, s10, 1
    s_cbranch_scc1 L_exit
    s_sleep 6
    s_branch L_pslow_45_l
    L_pslow_45_d:
    v_mov_b32 v253, s50
    s_mov_b64 exec, -1
    s_nop 4
    s_branch L_pdone_44
    L_pslow_48:
    v_mov_b32 v255, 0
    s_add_u32 s13, s20, 512
    v_writelane_b32 v255, s13, 0
    s_add_u32 s13, s20, 1536
    v_writelane_b32 v255, s13, 1
    s_add_u32 s13, s20, 2560
    v_writelane_b32 v255, s13, 2
    s_add_u32 s13, s20, 3584
    v_writelane_b32 v255, s13, 3
    s_add_u32 s13, s20, 16896
    v_writelane_b32 v255, s13, 4
    s_add_u32 s13, s20, 17920
    v_writelane_b32 v255, s13, 5
    s_add_u32 s13, s20, 18944
    v_writelane_b32 v255, s13, 6
    s_add_u32 s13, s20, 19968
    v_writelane_b32 v255, s13, 7
    s_mov_b64 exec, 0xff
    L_pslow_48_l:
    buffer_load_dword v253, v255, s[40:43], 0 offen sc1
    s_waitcnt vmcnt(0)
    v_cmp_ne_u32 vcc, s50, v253
    s_nop 4
    s_cbranch_vccz L_pslow_48_d
    s_sub_u32 s10, s10, 1
    s_cbranch_scc1 L_exit
    s_sleep 6
    s_branch L_pslow_48_l
    L_pslow_48_d:
    v_mov_b32 v253, s50
    s_mov_b64 exec, -1
    s_nop 4
    s_branch L_pdone_47
    L_pslow_53:
    v_mov_b32 v255, 0
    s_add_u32 s13, s23, 0
    v_writelane_b32 v255, s13, 0
    s_add_u32 s13, s23, 256
    v_writelane_b32 v255, s13, 1
    s_add_u32 s13, s23, 512
    v_writelane_b32 v255, s13, 2
    s_add_u32 s13, s23, 1792
    v_writelane_b32 v255, s13, 3
    s_add_u32 s13, s23, 2048
    v_writelane_b32 v255, s13, 4
    s_add_u32 s13, s23, 2304
    v_writelane_b32 v255, s13, 5
    s_add_u32 s13, s23, 3584
    v_writelane_b32 v255, s13, 6
    s_add_u32 s13, s23, 3840
    v_writelane_b32 v255, s13, 7
    s_add_u32 s13, s23, 4096
    v_writelane_b32 v255, s13, 8
    s_mov_b64 exec, 0x1ff
    L_pslow_53_l:
    buffer_load_dword v253, v255, s[40:43], 0 offen sc1
    s_waitcnt vmcnt(0)
    v_cmp_ne_u32 vcc, s50, v253
    s_nop 4
    s_cbranch_vccz L_pslow_53_d
    s_sub_u32 s10, s10, 1
    s_cbranch_scc1 L_exit
    s_sleep 6
    s_branch L_pslow_53_l
    L_pslow_53_d:
    v_mov_b32 v253, s50
    s_mov_b64 exec, -1
    s_nop 4
    s_branch L_pdone_52
    L_ep_57:
    v_mov_b32 v255, 0
    L_ep_57_l:
    global_load_dword v253, v255, s[32:33] sc1
    s_waitcnt vmcnt(0)
    v_readfirstlane_b32 s50, v253
    s_nop 4
    s_cmp_lg_u32 s50, 0
    s_cbranch_scc1 L_epd_58
    s_sub_u32 s10, s10, 1
    s_cbranch_scc1 L_exit
    s_sleep 4
    s_branch L_ep_57_l
    L_pslow_63:
    v_mov_b32 v255, 0
    s_add_u32 s13, s20, 0
    v_writelane_b32 v255, s13, 0
    s_add_u32 s13, s20, 16384
    v_writelane_b32 v255, s13, 1
    s_add_u32 s13, s20, 32768
    v_writelane_b32 v255, s13, 2
    s_add_u32 s13, s21, 0
    v_writelane_b32 v255, s13, 3
    s_add_u32 s13, s21, 16384
    v_writelane_b32 v255, s13, 4
    s_add_u32 s13, s21, 32768
    v_writelane_b32 v255, s13, 5
    s_add_u32 s13, s22, 256
    v_writelane_b32 v255, s13, 6
    s_add_u32 s13, s23, 256
    v_writelane_b32 v255, s13, 7
    s_mov_b64 exec, 0xff
    L_pslow_63_l:
    buffer_load_dword v253, v255, s[40:43], 0 offen sc1
    s_waitcnt vmcnt(0)
    v_cmp_ne_u32 vcc, s50, v253
    s_nop 4
    s_cbranch_vccz L_pslow_63_d
    s_sub_u32 s10, s10, 1
    s_cbranch_scc1 L_exit
    s_sleep 6
    s_branch L_pslow_63_l
    L_pslow_63_d:
    v_mov_b32 v253, s50
    s_mov_b64 exec, -1
    s_nop 4
    s_branch L_pdone_62
L_code_end:
    s_endpgm
.section .rodata,"a"
.p2align 6
.amdhsa_kernel sequential_preLN__sliding_block__glu_gated_geglu__prompt_kernel
  .amdhsa_next_free_vgpr 512
  .amdhsa_next_free_sgpr 102
  .amdhsa_accum_offset 256
  .amdhsa_group_segment_fixed_size 0
  .amdhsa_kernarg_size 80
  .amdhsa_user_sgpr_count 2
  .amdhsa_user_sgpr_kernarg_segment_ptr 1
  .amdhsa_system_sgpr_workgroup_id_x 1
.end_amdhsa_kernel
```
